```python
import torch

def _softmax(x, axis=-1):
    return torch.softmax(x, dim=axis)
def _gelu(x):
    return torch.nn.functional.gelu(x, approximate="tanh")
def _silu(x):
    return torch.nn.functional.silu(x)
def _sigmoid(x):
    return torch.sigmoid(x)
def _layernorm(x, axis=-1, eps=1e-5):
    m = x.mean(dim=axis, keepdim=True)
    v = x.var(dim=axis, keepdim=True, unbiased=False)
    return (x - m) / torch.sqrt(v + eps)
def _scatter_add(tgt, idx, src, axis=0):
    return tgt.clone().index_add_(axis, idx, src)
def _segment_sum(src, seg, n):
    out = torch.zeros((n,) + src.shape[1:], dtype=src.dtype)
    return out.index_add_(0, seg, src)
def _pad(x, pw):
    flat = tuple(v for pair in reversed(pw) for v in pair)
    return torch.nn.functional.pad(x, flat)

kernel_name = 'gated_mix__ssm_conv_s5__ssm_conv_s4__prompt'

def setup_inputs():

    _w = (lambda a: (lambda t: t.to(torch.bfloat16) if t.is_floating_point() else t)(torch.as_tensor(a)))
    def _A_setup():
        B, S, D = 1, 2048, 640
        P = D
        Lambda_re = -0.5 * (lambda _x: torch.exp(torch.as_tensor(_x)))((lambda *s: torch.randn(*s, dtype=torch.bfloat16) * 0.2)(P))
        Lambda_im = (lambda *s: torch.randn(*s, dtype=torch.bfloat16) * 0.4)(P) * 1.0
        B_re = (lambda *s: torch.randn(*s, dtype=torch.bfloat16) * 0.2)(P, D) * (D ** -0.5)
        B_im = (lambda *s: torch.randn(*s, dtype=torch.bfloat16) * 0.2)(P, D) * (D ** -0.5)
        C_re = (lambda *s: torch.randn(*s, dtype=torch.bfloat16) * 0.2)(D, P) * (P ** -0.5)
        C_im = (lambda *s: torch.randn(*s, dtype=torch.bfloat16) * 0.2)(D, P) * (P ** -0.5)
        log_dt = (lambda *s: torch.randn(*s, dtype=torch.bfloat16) * 0.2)(P) * 0.3 - 2.0
        Dskip = (lambda *s: torch.randn(*s, dtype=torch.bfloat16) * 0.05)(D)
        return {
            "x": _w((lambda *s: torch.randn(*s, dtype=torch.bfloat16) * 0.05)(B, S, D)),
            "Lambda_re": _w(Lambda_re),
            "Lambda_im": _w(Lambda_im),
            "B_re": _w(B_re),
            "B_im": _w(B_im),
            "C_re": _w(C_re),
            "C_im": _w(C_im),
            "log_dt": _w(log_dt),
            "Dskip": _w(Dskip),
        }
    _A_in = _A_setup()

    def _B_setup():
        B, L, D, N = 1, 2048, 640, 128
        A_re = -(lambda _x: torch.exp(torch.as_tensor(_x)))((lambda *s: torch.randn(*s, dtype=torch.bfloat16) * 3.2)(D, N))
        A_im = torch.pi * (lambda *s: torch.randn(*s, dtype=torch.bfloat16) * 0.05)(D, N)
        B_re = (lambda *s: torch.randn(*s, dtype=torch.bfloat16) * 0.1)(D, N)
        B_im = (lambda *s: torch.randn(*s, dtype=torch.bfloat16) * 0.1)(D, N)
        C_re = (lambda *s: torch.randn(*s, dtype=torch.bfloat16) * 0.1)(D, N)
        C_im = (lambda *s: torch.randn(*s, dtype=torch.bfloat16) * 0.1)(D, N)
        log_dt = (lambda *s: torch.randn(*s, dtype=torch.bfloat16) * 0.05)(D) * 0.5 - 4.0
        Dskip = (lambda *s: torch.randn(*s, dtype=torch.bfloat16) * 0.05)(D)
        return {
            "u": _w((lambda *s: torch.randn(*s, dtype=torch.bfloat16) * 0.05)(B, L, D)),
            "A_re": _w(A_re),
            "A_im": _w(A_im),
            "B_re": _w(B_re),
            "B_im": _w(B_im),
            "C_re": _w(C_re),
            "C_im": _w(C_im),
            "log_dt": _w(log_dt),
            "Dskip": _w(Dskip),
        }
    _B_in = _B_setup()

    return {
        "A_x": _A_in["x"],
        "A_Lambda_re": _A_in["Lambda_re"],
        "A_Lambda_im": _A_in["Lambda_im"],
        "A_B_re": _A_in["B_re"],
        "A_B_im": _A_in["B_im"],
        "A_C_re": _A_in["C_re"],
        "A_C_im": _A_in["C_im"],
        "A_log_dt": _A_in["log_dt"],
        "A_Dskip": _A_in["Dskip"],
        "B_u": _B_in["u"],
        "B_A_re": _B_in["A_re"],
        "B_A_im": _B_in["A_im"],
        "B_B_re": _B_in["B_re"],
        "B_B_im": _B_in["B_im"],
        "B_C_re": _B_in["C_re"],
        "B_C_im": _B_in["C_im"],
        "B_log_dt": _B_in["log_dt"],
        "B_Dskip": _B_in["Dskip"],
        "gate_w": _w((lambda *s: torch.randn(*s, dtype=torch.bfloat16) * 0.05)(640) * 16.0),
    }

def reference(A_x, A_Lambda_re, A_Lambda_im, A_B_re, A_B_im, A_C_re, A_C_im, A_log_dt, A_Dskip, B_u, B_A_re, B_A_im, B_B_re, B_B_im, B_C_re, B_C_im, B_log_dt, B_Dskip, gate_w):
    def _A_ref(x, Lambda_re, Lambda_im, B_re, B_im, C_re, C_im, log_dt, Dskip):
        Bsz, L, H = x.shape
        Lam = Lambda_re + 1j * Lambda_im
        Bmat = B_re + 1j * B_im
        Cmat = C_re + 1j * C_im
        dt = torch.exp(log_dt)
        Lam_bar = torch.exp(dt * Lam)
        B_bar = ((Lam_bar - 1.0) / Lam)[:, None] * Bmat
        Bu = torch.einsum("bld,pd->blp", x + 0j, B_bar)
        h = torch.zeros_like(Bu[:, 0, :])
        hs = []
        for t in range(L):
            h = Lam_bar[None, :] * h + Bu[:, t, :]
            hs.append(h)
        hseq = torch.stack(hs, 1)
        y = 2.0 * torch.einsum("blp,dp->bld", hseq, Cmat).real + x * Dskip[None, None, :]
        return y

    def _B_ref(u, A_re, A_im, B_re, B_im, C_re, C_im, log_dt, Dskip):
        Bsz, L, D = u.shape
        dt = torch.exp(log_dt)[:, None]
        A = A_re + 1j * A_im
        Bc = B_re + 1j * B_im
        Cc = C_re + 1j * C_im
        logdA = dt * A
        dB = dt * Bc
        l = (lambda x, dt: x.to(dt))(torch.arange(L), A_re.dtype)
        P = torch.exp(logdA[:, :, None] * l[None, None, :])
        K = torch.einsum("dn,dnl,dn->dl", Cc, P, dB).real
        L2 = 2 * L
        Kp = _pad(K, ((0, 0), (0, L)))
        up = (lambda x, *d: x.permute(*d))(u, 0, 2, 1)
        up = _pad(up, ((0, 0), (0, 0), (0, L)))
        Kf = (lambda x, axes=(-2,-1): torch.fft.rfft2(x.float(), dim=axes))(Kp[:, None, :], axes=(-2, -1))
        Uf = (lambda x, axes=(-2,-1): torch.fft.rfft2(x.float(), dim=axes))(up[:, :, None, :], axes=(-2, -1))
        Yf = Uf * Kf[None, :, :, :]
        y = (lambda x, s, axes=(-2,-1): torch.fft.irfft2(x, s=s, dim=axes).to(torch.bfloat16))(Yf, (1, L2), axes=(-2, -1))[:, :, 0, :L]
        y = (lambda x, *d: x.permute(*d))(y, 0, 2, 1) + u * Dskip[None, None, :]
        return y

    x = A_x
    g = _sigmoid((x * gate_w).sum(-1, keepdims=True))
    a = _A_ref(x, A_Lambda_re, A_Lambda_im, A_B_re, A_B_im, A_C_re, A_C_im, A_log_dt, A_Dskip)
    b = _B_ref(x, B_A_re, B_A_im, B_B_re, B_B_im, B_C_re, B_C_im, B_log_dt, B_Dskip)
    return g * a + (1 - g) * b
```

```asm
; @launch grid=(256,1,1) block=(512,1,1) lds=163840
.amdgcn_target "amdgcn-amd-amdhsa--gfx950"
.text
.globl gated_mix__ssm_conv_s5__ssm_conv_s4__prompt_kernel
.p2align 8
.type gated_mix__ssm_conv_s5__ssm_conv_s4__prompt_kernel,@function
gated_mix__ssm_conv_s5__ssm_conv_s4__prompt_kernel:
    s_cmp_ge_u32 s2, 256
    s_cbranch_scc1 L_exit
    s_load_dwordx16 s[16:31], s[0:1], 0
    s_load_dwordx16 s[32:47], s[0:1], 64
    s_load_dwordx8 s[48:55], s[0:1], 128
    s_load_dwordx4 s[56:59], s[0:1], 160
    v_lshrrev_b32 v1, 6, v0
    v_and_b32 v0, 63, v0
    v_readfirstlane_b32 s3, v1
    s_and_b32 s9, s2, 7
    s_lshr_b32 s10, s2, 3
    s_lshl_b32 s4, s9, 1
    s_lshr_b32 s11, s10, 4
    s_add_u32 s4, s4, s11
    s_and_b32 s5, s10, 15
    s_lshl_b32 s6, s9, 2
    s_lshr_b32 s11, s10, 3
    s_add_u32 s6, s6, s11
    s_and_b32 s7, s10, 7
    s_waitcnt lgkmcnt(0)
    s_load_dword s8, s[58:59], 0
    s_mov_b32 s60, s58
    s_and_b32 s61, s59, 0xffff
    s_mov_b32 s62, 25165824
    s_mov_b32 s63, 0x20000
    s_mov_b32 s64, s54
    s_and_b32 s65, s55, 0xffff
    s_mov_b32 s66, 5242880
    s_mov_b32 s67, 0x20000
    s_cmp_lt_u32 s3, 4
    s_cbranch_scc1 L_s5
    s_cmp_lt_u32 s3, 7
    s_cbranch_scc1 L_s4
    s_branch L_helper
L_helper:
    s_getpc_b64 s[12:13]
L_pc_anchor:
    s_add_u32 s12, s12, gated_mix__ssm_conv_s5__ssm_conv_s4__prompt_kernel - L_pc_anchor
    s_addc_u32 s13, s13, -1
    s_lshr_b32 s10, s2, 3
    s_mul_i32 s10, s10, 16
    v_add_u32 v148, s10, v0
    v_lshlrev_b32 v148, 7, v148
    v_min_u32 v148, L_exit - gated_mix__ssm_conv_s5__ssm_conv_s4__prompt_kernel, v148
    v_mov_b32 v149, s13
    v_add_co_u32 v148, vcc, s12, v148
    s_nop 1
    v_addc_co_u32 v149, vcc, 0, v149, vcc
    s_mov_b32 exec_lo, 0xffff
    s_mov_b32 exec_hi, 0x0
    global_load_dword v147, v[148:149], off
    s_mov_b64 exec, -1
    v_mov_b32 v142, s58
    v_mov_b32 v143, s59
    s_add_u32 s10, s26, 0
    s_addc_u32 s11, s27, 0
    v_writelane_b32 v142, s10, 0
    v_writelane_b32 v143, s11, 0
    s_add_u32 s10, s26, 819196
    s_addc_u32 s11, s27, 0
    v_writelane_b32 v142, s10, 1
    v_writelane_b32 v143, s11, 1
    s_add_u32 s10, s28, 0
    s_addc_u32 s11, s29, 0
    v_writelane_b32 v142, s10, 2
    v_writelane_b32 v143, s11, 2
    s_add_u32 s10, s28, 819196
    s_addc_u32 s11, s29, 0
    v_writelane_b32 v142, s10, 3
    v_writelane_b32 v143, s11, 3
    s_add_u32 s10, s54, 0
    s_addc_u32 s11, s55, 0
    v_writelane_b32 v142, s10, 4
    v_writelane_b32 v143, s11, 4
    s_add_u32 s10, s54, 2097152
    s_addc_u32 s11, s55, 0
    v_writelane_b32 v142, s10, 5
    v_writelane_b32 v143, s11, 5
    s_add_u32 s10, s54, 4194304
    s_addc_u32 s11, s55, 0
    v_writelane_b32 v142, s10, 6
    v_writelane_b32 v143, s11, 6
    s_add_u32 s10, s54, 5242876
    s_addc_u32 s11, s55, 0
    v_writelane_b32 v142, s10, 7
    v_writelane_b32 v143, s11, 7
    s_add_u32 s10, s58, 1048576
    s_addc_u32 s11, s59, 0
    v_writelane_b32 v142, s10, 8
    v_writelane_b32 v143, s11, 8
    s_add_u32 s10, s58, 2621440
    s_addc_u32 s11, s59, 0
    v_writelane_b32 v142, s10, 9
    v_writelane_b32 v143, s11, 9
    s_add_u32 s10, s58, 4194304
    s_addc_u32 s11, s59, 0
    v_writelane_b32 v142, s10, 10
    v_writelane_b32 v143, s11, 10
    s_add_u32 s10, s58, 6291456
    s_addc_u32 s11, s59, 0
    v_writelane_b32 v142, s10, 11
    v_writelane_b32 v143, s11, 11
    s_add_u32 s10, s58, 16777216
    s_addc_u32 s11, s59, 0
    v_writelane_b32 v142, s10, 12
    v_writelane_b32 v143, s11, 12
    s_add_u32 s10, s58, 18874368
    s_addc_u32 s11, s59, 0
    v_writelane_b32 v142, s10, 13
    v_writelane_b32 v143, s11, 13
    s_add_u32 s10, s58, 20971520
    s_addc_u32 s11, s59, 0
    v_writelane_b32 v142, s10, 14
    v_writelane_b32 v143, s11, 14
    s_add_u32 s10, s32, 0
    s_addc_u32 s11, s33, 0
    v_writelane_b32 v142, s10, 15
    v_writelane_b32 v143, s11, 15
    s_add_u32 s10, s50, 0
    s_addc_u32 s11, s51, 0
    v_writelane_b32 v142, s10, 16
    v_writelane_b32 v143, s11, 16
    s_mov_b32 exec_lo, 0x1ffff
    s_mov_b32 exec_hi, 0x0
    global_load_dword v141, v[142:143], off
    s_mov_b64 exec, -1
    s_mul_i32 s9, s4, 163840
    s_mul_i32 s10, s5, 80
    s_add_u32 s9, s9, s10
    s_add_u32 s68, s16, s9
    s_addc_u32 s69, s17, 0
    s_add_u32 s70, s68, 81920
    s_addc_u32 s71, s69, 0
    v_add_u32 v2, 0, v0
    v_mul_u32_u24 v3, 0xCCCD, v2
    v_lshrrev_b32 v3, 18, v3
    v_mul_u32_u24 v4, 5, v3
    v_sub_u32 v4, v2, v4
    v_lshlrev_b32 v4, 4, v4
    v_mul_u32_u24 v3, 1280, v3
    v_add_u32 v8, v3, v4
    v_add_u32 v2, 64, v0
    v_mul_u32_u24 v3, 0xCCCD, v2
    v_lshrrev_b32 v3, 18, v3
    v_mul_u32_u24 v4, 5, v3
    v_sub_u32 v4, v2, v4
    v_lshlrev_b32 v4, 4, v4
    v_mul_u32_u24 v3, 1280, v3
    v_add_u32 v9, v3, v4
    v_add_u32 v2, 128, v0
    v_mul_u32_u24 v3, 0xCCCD, v2
    v_lshrrev_b32 v3, 18, v3
    v_mul_u32_u24 v4, 5, v3
    v_sub_u32 v4, v2, v4
    v_lshlrev_b32 v4, 4, v4
    v_mul_u32_u24 v3, 1280, v3
    v_add_u32 v10, v3, v4
    v_add_u32 v2, 192, v0
    v_mul_u32_u24 v3, 0xCCCD, v2
    v_lshrrev_b32 v3, 18, v3
    v_mul_u32_u24 v4, 5, v3
    v_sub_u32 v4, v2, v4
    v_lshlrev_b32 v4, 4, v4
    v_mul_u32_u24 v3, 1280, v3
    v_add_u32 v11, v3, v4
    v_add_u32 v2, 256, v0
    v_mul_u32_u24 v3, 0xCCCD, v2
    v_lshrrev_b32 v3, 18, v3
    v_mul_u32_u24 v4, 5, v3
    v_sub_u32 v4, v2, v4
    v_lshlrev_b32 v4, 4, v4
    v_mul_u32_u24 v3, 1280, v3
    v_add_u32 v12, v3, v4
    s_mov_b32 m0, 151552
    s_nop 0
    global_load_lds_dwordx4 v8, s[68:69]
    s_mov_b32 m0, 152576
    s_nop 0
    global_load_lds_dwordx4 v9, s[68:69]
    s_mov_b32 m0, 153600
    s_nop 0
    global_load_lds_dwordx4 v10, s[68:69]
    s_mov_b32 m0, 154624
    s_nop 0
    global_load_lds_dwordx4 v11, s[68:69]
    s_mov_b32 m0, 155648
    s_nop 0
    global_load_lds_dwordx4 v12, s[68:69]
    s_mov_b32 m0, 156672
    s_nop 0
    global_load_lds_dwordx4 v8, s[70:71]
    s_mov_b32 m0, 157696
    s_nop 0
    global_load_lds_dwordx4 v9, s[70:71]
    s_mov_b32 m0, 158720
    s_nop 0
    global_load_lds_dwordx4 v10, s[70:71]
    s_mov_b32 m0, 159744
    s_nop 0
    global_load_lds_dwordx4 v11, s[70:71]
    s_mov_b32 m0, 160768
    s_nop 0
    global_load_lds_dwordx4 v12, s[70:71]
    s_lshl_b32 s9, s4, 7
    s_lshl_b32 s10, s5, 3
    s_add_u32 s72, s9, s10
    s_mul_i32 s9, s72, 1280
    s_add_u32 s74, s16, s9
    s_addc_u32 s75, s17, 0
    v_lshrrev_b32 v2, 3, v0
    v_mul_u32_u24 v2, 1280, v2
    v_and_b32 v3, 7, v0
    v_lshlrev_b32 v3, 4, v3
    v_add_u32 v2, v2, v3
    global_load_dwordx4 v[16:19], v2, s[74:75] offset:0
    global_load_dwordx4 v[20:23], v2, s[74:75] offset:128
    global_load_dwordx4 v[24:27], v2, s[74:75] offset:256
    global_load_dwordx4 v[28:31], v2, s[74:75] offset:384
    global_load_dwordx4 v[32:35], v2, s[74:75] offset:512
    global_load_dwordx4 v[36:39], v2, s[74:75] offset:640
    global_load_dwordx4 v[40:43], v2, s[74:75] offset:768
    global_load_dwordx4 v[44:47], v2, s[74:75] offset:896
    global_load_dwordx4 v[48:51], v2, s[74:75] offset:1024
    global_load_dwordx4 v[52:55], v2, s[74:75] offset:1152
    global_load_dwordx4 v[56:59], v3, s[52:53] offset:0
    global_load_dwordx4 v[60:63], v3, s[52:53] offset:128
    global_load_dwordx4 v[64:67], v3, s[52:53] offset:256
    global_load_dwordx4 v[68:71], v3, s[52:53] offset:384
    global_load_dwordx4 v[72:75], v3, s[52:53] offset:512
    global_load_dwordx4 v[76:79], v3, s[52:53] offset:640
    global_load_dwordx4 v[80:83], v3, s[52:53] offset:768
    global_load_dwordx4 v[84:87], v3, s[52:53] offset:896
    global_load_dwordx4 v[88:91], v3, s[52:53] offset:1024
    global_load_dwordx4 v[92:95], v3, s[52:53] offset:1152
    s_mov_b32 s76, s72
    v_lshrrev_b32 v2, 3, v0
    v_and_b32 v3, 6, v2
    v_and_b32 v4, 7, v0
    v_xor_b32 v3, v3, v4
    v_lshlrev_b32 v3, 4, v3
    v_lshrrev_b32 v4, 2, v2
    v_lshlrev_b32 v4, 3, v4
    v_and_b32 v5, 3, v2
    v_add_u32 v4, v4, v5
    v_add_u32 v5, 0, v2
    v_mul_u32_u24 v5, 1280, v5
    v_add_u32 v11, v5, v3
    v_add_u32 v5, 8, v2
    v_mul_u32_u24 v5, 1280, v5
    v_add_u32 v12, v5, v3
    v_add_u32 v5, 16, v2
    v_mul_u32_u24 v5, 1280, v5
    v_add_u32 v13, v5, v3
    v_add_u32 v5, 24, v2
    v_mul_u32_u24 v5, 1280, v5
    v_add_u32 v14, v5, v3
    v_add_u32 v5, 32, v2
    v_mul_u32_u24 v5, 1280, v5
    v_add_u32 v15, v5, v3
    s_mul_i32 s9, s4, 163840
    s_add_u32 s68, s16, s9
    s_addc_u32 s69, s17, 0
    s_mul_i32 s9, s5, 51200
    s_add_u32 s70, s22, s9
    s_addc_u32 s71, s23, 0
    s_add_u32 s72, s24, s9
    s_addc_u32 s73, s25, 0
    v_mov_b32 v100, 0
    v_mov_b32 v101, 0
    v_mov_b32 v102, 0
    v_mov_b32 v103, 0
    v_lshlrev_b32 v104, 4, v0
    v_add_u32 v104, 163072, v104
    s_mov_b32 exec_lo, 0xffffffff
    s_mov_b32 exec_hi, 0xfff
    ds_write_b128 v104, v[100:103]
    s_mov_b64 exec, -1
    s_waitcnt lgkmcnt(0)
    s_barrier
    s_mul_i32 s8, s8, 0x9E3779B1
    s_add_u32 s8, s8, 0x7F4A7C15
    s_getreg_b32 s88, hwreg(HW_REG_XCC_ID)
    s_and_b32 s88, s88, 15
    s_lshl_b32 s88, s88, 8
    s_or_b32 s88, s88, 0x1000
    s_xor_b32 s88, s88, s8
    v_lshrrev_b32 v4, 4, v0
    v_lshlrev_b32 v4, 3, v4
    v_bfe_u32 v5, v0, 2, 2
    v_add_u32 v4, v4, v5
    v_mul_u32_u24 v4, 80, v4
    v_and_b32 v5, 3, v0
    v_lshlrev_b32 v5, 3, v5
    v_add_u32 v4, v4, v5
    v_add_u32 v4, 151552, v4
    s_waitcnt vmcnt(20)
    ds_read_b64_tr_b16 v[96:97], v4 offset:0
    ds_read_b64_tr_b16 v[98:99], v4 offset:320
    ds_read_b64_tr_b16 v[100:101], v4 offset:2560
    ds_read_b64_tr_b16 v[102:103], v4 offset:2880
    ds_read_b64_tr_b16 v[104:105], v4 offset:5120
    ds_read_b64_tr_b16 v[106:107], v4 offset:5440
    ds_read_b64_tr_b16 v[108:109], v4 offset:7680
    ds_read_b64_tr_b16 v[110:111], v4 offset:8000
    ds_read_b64_tr_b16 v[112:113], v4 offset:32
    ds_read_b64_tr_b16 v[114:115], v4 offset:352
    ds_read_b64_tr_b16 v[116:117], v4 offset:2592
    ds_read_b64_tr_b16 v[118:119], v4 offset:2912
    ds_read_b64_tr_b16 v[120:121], v4 offset:5152
    ds_read_b64_tr_b16 v[122:123], v4 offset:5472
    ds_read_b64_tr_b16 v[124:125], v4 offset:7712
    ds_read_b64_tr_b16 v[126:127], v4 offset:8032
    ds_read_b64_tr_b16 v[128:129], v4 offset:64
    ds_read_b64_tr_b16 v[130:131], v4 offset:384
    ds_read_b64_tr_b16 v[132:133], v4 offset:2624
    ds_read_b64_tr_b16 v[134:135], v4 offset:2944
    ds_read_b64_tr_b16 v[136:137], v4 offset:5184
    ds_read_b64_tr_b16 v[138:139], v4 offset:5504
    ds_read_b64_tr_b16 v[140:141], v4 offset:7744
    ds_read_b64_tr_b16 v[142:143], v4 offset:8064
    v_and_b32 v5, 15, v0
    v_mul_u32_u24 v5, 272, v5
    v_lshrrev_b32 v6, 4, v0
    v_lshlrev_b32 v6, 4, v6
    v_add_u32 v5, v5, v6
    v_add_u32 v5, 151552, v5
    s_waitcnt lgkmcnt(0)
    ds_write_b128 v5, v[96:99] offset:0
    ds_write_b128 v5, v[100:103] offset:64
    ds_write_b128 v5, v[104:107] offset:128
    ds_write_b128 v5, v[108:111] offset:192
    ds_write_b128 v5, v[112:115] offset:4352
    ds_write_b128 v5, v[116:119] offset:4416
    ds_write_b128 v5, v[120:123] offset:4480
    ds_write_b128 v5, v[124:127] offset:4544
    s_mov_b32 exec_lo, 0x00FF00FF
    s_mov_b32 exec_hi, 0x00FF00FF
    ds_write_b128 v5, v[128:131] offset:8704
    ds_write_b128 v5, v[132:135] offset:8768
    ds_write_b128 v5, v[136:139] offset:8832
    ds_write_b128 v5, v[140:143] offset:8896
    s_mov_b64 exec, -1
    v_lshrrev_b32 v6, 4, v0
    v_mul_u32_u24 v5, 272, v6
    v_and_b32 v7, 15, v0
    v_lshlrev_b32 v7, 4, v7
    v_add_u32 v5, v5, v7
    v_add_u32 v5, 151552, v5
    v_lshlrev_b32 v6, 12, v6
    v_add_u32 v6, v6, v7
    s_waitcnt lgkmcnt(0)
    ds_read_b128 v[96:99], v5 offset:0
    ds_read_b128 v[100:103], v5 offset:1088
    ds_read_b128 v[104:107], v5 offset:2176
    ds_read_b128 v[108:111], v5 offset:3264
    ds_read_b128 v[112:115], v5 offset:4352
    ds_read_b128 v[116:119], v5 offset:5440
    ds_read_b128 v[120:123], v5 offset:6528
    ds_read_b128 v[124:127], v5 offset:7616
    ds_read_b128 v[128:131], v5 offset:8704
    ds_read_b128 v[132:135], v5 offset:9792
    s_mul_i32 s9, s5, 163840
    s_lshl_b32 s10, s4, 8
    s_add_u32 s9, s9, s10
    s_add_u32 s9, s9, 1048576
    s_waitcnt lgkmcnt(9)
    buffer_store_dwordx4 v[96:99], v6, s[60:63], s9 offen sc1
    s_add_u32 s9, s9, 16384
    s_waitcnt lgkmcnt(8)
    buffer_store_dwordx4 v[100:103], v6, s[60:63], s9 offen sc1
    s_add_u32 s9, s9, 16384
    s_waitcnt lgkmcnt(7)
    buffer_store_dwordx4 v[104:107], v6, s[60:63], s9 offen sc1
    s_add_u32 s9, s9, 16384
    s_waitcnt lgkmcnt(6)
    buffer_store_dwordx4 v[108:111], v6, s[60:63], s9 offen sc1
    s_add_u32 s9, s9, 16384
    s_waitcnt lgkmcnt(5)
    buffer_store_dwordx4 v[112:115], v6, s[60:63], s9 offen sc1
    s_add_u32 s9, s9, 16384
    s_waitcnt lgkmcnt(4)
    buffer_store_dwordx4 v[116:119], v6, s[60:63], s9 offen sc1
    s_add_u32 s9, s9, 16384
    s_waitcnt lgkmcnt(3)
    buffer_store_dwordx4 v[120:123], v6, s[60:63], s9 offen sc1
    s_add_u32 s9, s9, 16384
    s_waitcnt lgkmcnt(2)
    buffer_store_dwordx4 v[124:127], v6, s[60:63], s9 offen sc1
    s_add_u32 s9, s9, 16384
    s_waitcnt lgkmcnt(1)
    buffer_store_dwordx4 v[128:131], v6, s[60:63], s9 offen sc1
    s_add_u32 s9, s9, 16384
    s_waitcnt lgkmcnt(0)
    buffer_store_dwordx4 v[132:135], v6, s[60:63], s9 offen sc1
    s_waitcnt vmcnt(10)
    v_mov_b32 v8, 0
    v_mov_b32 v9, 0
    v_dot2_f32_bf16 v8, v16, v56, v8
    v_dot2_f32_bf16 v9, v17, v57, v9
    v_dot2_f32_bf16 v8, v18, v58, v8
    v_dot2_f32_bf16 v9, v19, v59, v9
    v_dot2_f32_bf16 v8, v20, v60, v8
    v_dot2_f32_bf16 v9, v21, v61, v9
    v_dot2_f32_bf16 v8, v22, v62, v8
    v_dot2_f32_bf16 v9, v23, v63, v9
    v_dot2_f32_bf16 v8, v24, v64, v8
    v_dot2_f32_bf16 v9, v25, v65, v9
    v_dot2_f32_bf16 v8, v26, v66, v8
    v_dot2_f32_bf16 v9, v27, v67, v9
    v_dot2_f32_bf16 v8, v28, v68, v8
    v_dot2_f32_bf16 v9, v29, v69, v9
    v_dot2_f32_bf16 v8, v30, v70, v8
    v_dot2_f32_bf16 v9, v31, v71, v9
    v_dot2_f32_bf16 v8, v32, v72, v8
    v_dot2_f32_bf16 v9, v33, v73, v9
    v_dot2_f32_bf16 v8, v34, v74, v8
    v_dot2_f32_bf16 v9, v35, v75, v9
    v_dot2_f32_bf16 v8, v36, v76, v8
    v_dot2_f32_bf16 v9, v37, v77, v9
    v_dot2_f32_bf16 v8, v38, v78, v8
    v_dot2_f32_bf16 v9, v39, v79, v9
    v_dot2_f32_bf16 v8, v40, v80, v8
    v_dot2_f32_bf16 v9, v41, v81, v9
    v_dot2_f32_bf16 v8, v42, v82, v8
    v_dot2_f32_bf16 v9, v43, v83, v9
    v_dot2_f32_bf16 v8, v44, v84, v8
    v_dot2_f32_bf16 v9, v45, v85, v9
    v_dot2_f32_bf16 v8, v46, v86, v8
    v_dot2_f32_bf16 v9, v47, v87, v9
    v_dot2_f32_bf16 v8, v48, v88, v8
    v_dot2_f32_bf16 v9, v49, v89, v9
    v_dot2_f32_bf16 v8, v50, v90, v8
    v_dot2_f32_bf16 v9, v51, v91, v9
    v_dot2_f32_bf16 v8, v52, v92, v8
    v_dot2_f32_bf16 v9, v53, v93, v9
    v_dot2_f32_bf16 v8, v54, v94, v8
    v_dot2_f32_bf16 v9, v55, v95, v9
    s_nop 2
    v_add_f32 v8, v8, v9
    s_nop 1
    v_add_f32_dpp v8, v8, v8 quad_perm:[1,0,3,2] row_mask:0xf bank_mask:0xf
    s_nop 1
    v_add_f32_dpp v8, v8, v8 quad_perm:[2,3,0,1] row_mask:0xf bank_mask:0xf
    s_nop 1
    v_add_f32_dpp v8, v8, v8 row_half_mirror row_mask:0xf bank_mask:0xf
    v_mul_f32 v8, 0xBFB8AA3B, v8
    v_exp_f32 v8, v8
    s_nop 0
    v_add_f32 v8, 1.0, v8
    v_rcp_f32 v8, v8
    s_nop 0
    v_cvt_pk_bf16_f32 v8, v8, v8
    v_lshlrev_b32 v8, 16, v8
    v_mov_b32 v9, s8
    s_mov_b32 exec_lo, 0x01010101
    s_mov_b32 exec_hi, 0x01010101
    v_and_b32 v10, 0x38, v0
    s_lshl_b32 s9, s76, 3
    s_add_u32 s9, s9, 32768
    buffer_store_dwordx2 v[8:9], v10, s[60:63], s9 offen sc1
    s_mov_b64 exec, -1
    s_and_b32 s9, s2, 7
    s_lshl_b32 s9, s9, 7
    s_lshr_b32 s10, s2, 3
    s_lshl_b32 s10, s10, 2
    s_add_u32 s9, s9, s10
    s_add_u32 s9, s9, 24576
    v_mov_b32 v4, s88
    v_mov_b32 v5, 0
    s_mov_b64 exec, 1
    buffer_store_dword v4, v5, s[60:63], s9 offen sc1
    s_mov_b64 exec, -1
    v_and_b32 v3, 3, v0
    v_lshlrev_b32 v3, 2, v3
    v_add_u32 v3, 163104, v3
    s_lshr_b32 s86, s2, 7
    s_mul_i32 s86, s86, 5
    s_add_u32 s86, s86, s5
    s_and_b32 s9, s2, 7
    s_add_u32 s86, s86, s9
    s_cmp_ge_u32 s86, 10
    s_cselect_b32 s9, 10, 0
    s_sub_u32 s86, s86, s9
    s_cmp_ge_u32 s86, 10
    s_cselect_b32 s9, 10, 0
    s_sub_u32 s86, s86, s9
    s_cmp_ge_u32 s86, 10
    s_cselect_b32 s9, 10, 0
    s_sub_u32 s86, s86, s9
    s_lshl_b32 s9, s86, 7
    s_add_u32 s70, s70, s9
    s_addc_u32 s71, s71, 0
    s_add_u32 s72, s72, s9
    s_addc_u32 s73, s73, 0
    s_sub_u32 s78, s70, 1280
    s_subb_u32 s79, s71, 0
    s_sub_u32 s80, s72, 1280
    s_subb_u32 s81, s73, 0
    s_cmp_ge_u32 s86, 10
    s_cselect_b32 s82, s78, s70
    s_cselect_b32 s83, s79, s71
    s_cselect_b32 s84, s80, s72
    s_cselect_b32 s85, s81, s73
    s_mov_b32 m0, 53248
    s_nop 0
    global_load_lds_dwordx4 v11, s[82:83] offset:0
    s_mov_b32 m0, 54272
    s_nop 0
    global_load_lds_dwordx4 v11, s[84:85] offset:0
    s_mov_b32 m0, 55296
    s_nop 0
    global_load_lds_dwordx4 v12, s[82:83] offset:0
    s_mov_b32 m0, 56320
    s_nop 0
    global_load_lds_dwordx4 v12, s[84:85] offset:0
    s_mov_b32 m0, 57344
    s_nop 0
    global_load_lds_dwordx4 v13, s[82:83] offset:0
    s_mov_b32 m0, 58368
    s_nop 0
    global_load_lds_dwordx4 v13, s[84:85] offset:0
    s_mov_b32 m0, 59392
    s_nop 0
    global_load_lds_dwordx4 v14, s[82:83] offset:0
    s_mov_b32 m0, 60416
    s_nop 0
    global_load_lds_dwordx4 v14, s[84:85] offset:0
    s_mov_b32 m0, 61440
    s_nop 0
    global_load_lds_dwordx4 v15, s[82:83] offset:0
    s_mov_b32 m0, 62464
    s_nop 0
    global_load_lds_dwordx4 v15, s[84:85] offset:0
    s_cmp_ge_u32 s86, 9
    s_cselect_b32 s82, s78, s70
    s_cselect_b32 s83, s79, s71
    s_cselect_b32 s84, s80, s72
    s_cselect_b32 s85, s81, s73
    s_mov_b32 m0, 63360
    s_nop 0
    global_load_lds_dwordx4 v11, s[82:83] offset:128
    s_mov_b32 m0, 64384
    s_nop 0
    global_load_lds_dwordx4 v11, s[84:85] offset:128
    s_mov_b32 m0, 65408
    s_nop 0
    global_load_lds_dwordx4 v12, s[82:83] offset:128
    s_mov_b32 m0, 66432
    s_nop 0
    global_load_lds_dwordx4 v12, s[84:85] offset:128
    s_mov_b32 m0, 67456
    s_nop 0
    global_load_lds_dwordx4 v13, s[82:83] offset:128
    s_mov_b32 m0, 68480
    s_nop 0
    global_load_lds_dwordx4 v13, s[84:85] offset:128
    s_mov_b32 m0, 69504
    s_nop 0
    global_load_lds_dwordx4 v14, s[82:83] offset:128
    s_mov_b32 m0, 70528
    s_nop 0
    global_load_lds_dwordx4 v14, s[84:85] offset:128
    s_mov_b32 m0, 71552
    s_nop 0
    global_load_lds_dwordx4 v15, s[82:83] offset:128
    s_mov_b32 m0, 72576
    s_nop 0
    global_load_lds_dwordx4 v15, s[84:85] offset:128
    s_cmp_ge_u32 s86, 8
    s_cselect_b32 s82, s78, s70
    s_cselect_b32 s83, s79, s71
    s_cselect_b32 s84, s80, s72
    s_cselect_b32 s85, s81, s73
    s_mov_b32 m0, 73472
    s_nop 0
    global_load_lds_dwordx4 v11, s[82:83] offset:256
    s_mov_b32 m0, 74496
    s_nop 0
    global_load_lds_dwordx4 v11, s[84:85] offset:256
    s_mov_b32 m0, 75520
    s_nop 0
    global_load_lds_dwordx4 v12, s[82:83] offset:256
    s_mov_b32 m0, 76544
    s_nop 0
    global_load_lds_dwordx4 v12, s[84:85] offset:256
    s_mov_b32 m0, 77568
    s_nop 0
    global_load_lds_dwordx4 v13, s[82:83] offset:256
    s_mov_b32 m0, 78592
    s_nop 0
    global_load_lds_dwordx4 v13, s[84:85] offset:256
    s_mov_b32 m0, 79616
    s_nop 0
    global_load_lds_dwordx4 v14, s[82:83] offset:256
    s_mov_b32 m0, 80640
    s_nop 0
    global_load_lds_dwordx4 v14, s[84:85] offset:256
    s_mov_b32 m0, 81664
    s_nop 0
    global_load_lds_dwordx4 v15, s[82:83] offset:256
    s_mov_b32 m0, 82688
    s_nop 0
    global_load_lds_dwordx4 v15, s[84:85] offset:256
    s_cmp_ge_u32 s86, 7
    s_cselect_b32 s82, s78, s70
    s_cselect_b32 s83, s79, s71
    s_cselect_b32 s84, s80, s72
    s_cselect_b32 s85, s81, s73
    s_mov_b32 m0, 83584
    s_nop 0
    global_load_lds_dwordx4 v11, s[82:83] offset:384
    s_mov_b32 m0, 84608
    s_nop 0
    global_load_lds_dwordx4 v11, s[84:85] offset:384
    s_mov_b32 m0, 85632
    s_nop 0
    global_load_lds_dwordx4 v12, s[82:83] offset:384
    s_mov_b32 m0, 86656
    s_nop 0
    global_load_lds_dwordx4 v12, s[84:85] offset:384
    s_mov_b32 m0, 87680
    s_nop 0
    global_load_lds_dwordx4 v13, s[82:83] offset:384
    s_mov_b32 m0, 88704
    s_nop 0
    global_load_lds_dwordx4 v13, s[84:85] offset:384
    s_mov_b32 m0, 89728
    s_nop 0
    global_load_lds_dwordx4 v14, s[82:83] offset:384
    s_mov_b32 m0, 90752
    s_nop 0
    global_load_lds_dwordx4 v14, s[84:85] offset:384
    s_mov_b32 m0, 91776
    s_nop 0
    global_load_lds_dwordx4 v15, s[82:83] offset:384
    s_mov_b32 m0, 92800
    s_nop 0
    global_load_lds_dwordx4 v15, s[84:85] offset:384
    s_waitcnt vmcnt(40)
    s_lshl_b32 s9, s5, 6
    s_lshl_b32 s10, s4, 2
    s_add_u32 s9, s9, s10
    s_add_u32 s9, s9, 4096
    v_mov_b32 v4, s8
    v_mov_b32 v5, 0
    s_mov_b64 exec, 1
    buffer_store_dword v4, v5, s[60:63], s9 offen sc1
    s_mov_b64 exec, -1
    s_waitcnt vmcnt(31)
    v_mov_b32 v4, 163080
    v_mov_b32 v5, 1
    s_mov_b64 exec, 1
    ds_write_b32 v4, v5
    s_mov_b64 exec, -1
    s_waitcnt vmcnt(21)
    v_mov_b32 v4, 163080
    v_mov_b32 v5, 2
    s_mov_b64 exec, 1
    ds_write_b32 v4, v5
    s_mov_b64 exec, -1
    s_waitcnt vmcnt(11)
    v_mov_b32 v4, 163080
    v_mov_b32 v5, 3
    s_mov_b64 exec, 1
    ds_write_b32 v4, v5
    s_mov_b64 exec, -1
    s_mov_b32 s14, 640000
L_ldw_1:
    ds_read_b32 v2, v3
    s_waitcnt lgkmcnt(0)
    v_cmp_gt_u32 vcc, 1, v2
    s_cbranch_vccz L_ldd_2
    s_sub_u32 s14, s14, 1
    s_cmp_lg_u32 s14, 0
    s_cbranch_scc1 L_ldw_1
L_ldd_2:
    s_cmp_ge_u32 s86, 6
    s_cselect_b32 s82, s78, s70
    s_cselect_b32 s83, s79, s71
    s_cselect_b32 s84, s80, s72
    s_cselect_b32 s85, s81, s73
    s_mov_b32 m0, 52736
    s_nop 0
    global_load_lds_dwordx4 v11, s[82:83] offset:512
    s_mov_b32 m0, 53760
    s_nop 0
    global_load_lds_dwordx4 v11, s[84:85] offset:512
    s_mov_b32 m0, 54784
    s_nop 0
    global_load_lds_dwordx4 v12, s[82:83] offset:512
    s_mov_b32 m0, 55808
    s_nop 0
    global_load_lds_dwordx4 v12, s[84:85] offset:512
    s_mov_b32 m0, 56832
    s_nop 0
    global_load_lds_dwordx4 v13, s[82:83] offset:512
    s_mov_b32 m0, 57856
    s_nop 0
    global_load_lds_dwordx4 v13, s[84:85] offset:512
    s_mov_b32 m0, 58880
    s_nop 0
    global_load_lds_dwordx4 v14, s[82:83] offset:512
    s_mov_b32 m0, 59904
    s_nop 0
    global_load_lds_dwordx4 v14, s[84:85] offset:512
    s_mov_b32 m0, 60928
    s_nop 0
    global_load_lds_dwordx4 v15, s[82:83] offset:512
    s_mov_b32 m0, 61952
    s_nop 0
    global_load_lds_dwordx4 v15, s[84:85] offset:512
    s_waitcnt vmcnt(10)
    v_mov_b32 v4, 163080
    v_mov_b32 v5, 4
    s_mov_b64 exec, 1
    ds_write_b32 v4, v5
    s_mov_b64 exec, -1
    s_mov_b32 s14, 640000
L_ldw_3:
    ds_read_b32 v2, v3
    s_waitcnt lgkmcnt(0)
    v_cmp_gt_u32 vcc, 2, v2
    s_cbranch_vccz L_ldd_4
    s_sub_u32 s14, s14, 1
    s_cmp_lg_u32 s14, 0
    s_cbranch_scc1 L_ldw_3
L_ldd_4:
    s_cmp_ge_u32 s86, 5
    s_cselect_b32 s82, s78, s70
    s_cselect_b32 s83, s79, s71
    s_cselect_b32 s84, s80, s72
    s_cselect_b32 s85, s81, s73
    s_mov_b32 m0, 62848
    s_nop 0
    global_load_lds_dwordx4 v11, s[82:83] offset:640
    s_mov_b32 m0, 63872
    s_nop 0
    global_load_lds_dwordx4 v11, s[84:85] offset:640
    s_mov_b32 m0, 64896
    s_nop 0
    global_load_lds_dwordx4 v12, s[82:83] offset:640
    s_mov_b32 m0, 65920
    s_nop 0
    global_load_lds_dwordx4 v12, s[84:85] offset:640
    s_mov_b32 m0, 66944
    s_nop 0
    global_load_lds_dwordx4 v13, s[82:83] offset:640
    s_mov_b32 m0, 67968
    s_nop 0
    global_load_lds_dwordx4 v13, s[84:85] offset:640
    s_mov_b32 m0, 68992
    s_nop 0
    global_load_lds_dwordx4 v14, s[82:83] offset:640
    s_mov_b32 m0, 70016
    s_nop 0
    global_load_lds_dwordx4 v14, s[84:85] offset:640
    s_mov_b32 m0, 71040
    s_nop 0
    global_load_lds_dwordx4 v15, s[82:83] offset:640
    s_mov_b32 m0, 72064
    s_nop 0
    global_load_lds_dwordx4 v15, s[84:85] offset:640
    s_waitcnt vmcnt(10)
    v_mov_b32 v4, 163080
    v_mov_b32 v5, 5
    s_mov_b64 exec, 1
    ds_write_b32 v4, v5
    s_mov_b64 exec, -1
    s_mov_b32 s14, 640000
L_ldw_5:
    ds_read_b32 v2, v3
    s_waitcnt lgkmcnt(0)
    v_cmp_gt_u32 vcc, 3, v2
    s_cbranch_vccz L_ldd_6
    s_sub_u32 s14, s14, 1
    s_cmp_lg_u32 s14, 0
    s_cbranch_scc1 L_ldw_5
L_ldd_6:
    s_cmp_ge_u32 s86, 4
    s_cselect_b32 s82, s78, s70
    s_cselect_b32 s83, s79, s71
    s_cselect_b32 s84, s80, s72
    s_cselect_b32 s85, s81, s73
    s_mov_b32 m0, 72960
    s_nop 0
    global_load_lds_dwordx4 v11, s[82:83] offset:768
    s_mov_b32 m0, 73984
    s_nop 0
    global_load_lds_dwordx4 v11, s[84:85] offset:768
    s_mov_b32 m0, 75008
    s_nop 0
    global_load_lds_dwordx4 v12, s[82:83] offset:768
    s_mov_b32 m0, 76032
    s_nop 0
    global_load_lds_dwordx4 v12, s[84:85] offset:768
    s_mov_b32 m0, 77056
    s_nop 0
    global_load_lds_dwordx4 v13, s[82:83] offset:768
    s_mov_b32 m0, 78080
    s_nop 0
    global_load_lds_dwordx4 v13, s[84:85] offset:768
    s_mov_b32 m0, 79104
    s_nop 0
    global_load_lds_dwordx4 v14, s[82:83] offset:768
    s_mov_b32 m0, 80128
    s_nop 0
    global_load_lds_dwordx4 v14, s[84:85] offset:768
    s_mov_b32 m0, 81152
    s_nop 0
    global_load_lds_dwordx4 v15, s[82:83] offset:768
    s_mov_b32 m0, 82176
    s_nop 0
    global_load_lds_dwordx4 v15, s[84:85] offset:768
    s_waitcnt vmcnt(10)
    v_mov_b32 v4, 163080
    v_mov_b32 v5, 6
    s_mov_b64 exec, 1
    ds_write_b32 v4, v5
    s_mov_b64 exec, -1
    s_mov_b32 s14, 640000
L_ldw_7:
    ds_read_b32 v2, v3
    s_waitcnt lgkmcnt(0)
    v_cmp_gt_u32 vcc, 4, v2
    s_cbranch_vccz L_ldd_8
    s_sub_u32 s14, s14, 1
    s_cmp_lg_u32 s14, 0
    s_cbranch_scc1 L_ldw_7
L_ldd_8:
    s_cmp_ge_u32 s86, 3
    s_cselect_b32 s82, s78, s70
    s_cselect_b32 s83, s79, s71
    s_cselect_b32 s84, s80, s72
    s_cselect_b32 s85, s81, s73
    s_mov_b32 m0, 83072
    s_nop 0
    global_load_lds_dwordx4 v11, s[82:83] offset:896
    s_mov_b32 m0, 84096
    s_nop 0
    global_load_lds_dwordx4 v11, s[84:85] offset:896
    s_mov_b32 m0, 85120
    s_nop 0
    global_load_lds_dwordx4 v12, s[82:83] offset:896
    s_mov_b32 m0, 86144
    s_nop 0
    global_load_lds_dwordx4 v12, s[84:85] offset:896
    s_mov_b32 m0, 87168
    s_nop 0
    global_load_lds_dwordx4 v13, s[82:83] offset:896
    s_mov_b32 m0, 88192
    s_nop 0
    global_load_lds_dwordx4 v13, s[84:85] offset:896
    s_mov_b32 m0, 89216
    s_nop 0
    global_load_lds_dwordx4 v14, s[82:83] offset:896
    s_mov_b32 m0, 90240
    s_nop 0
    global_load_lds_dwordx4 v14, s[84:85] offset:896
    s_mov_b32 m0, 91264
    s_nop 0
    global_load_lds_dwordx4 v15, s[82:83] offset:896
    s_mov_b32 m0, 92288
    s_nop 0
    global_load_lds_dwordx4 v15, s[84:85] offset:896
    s_waitcnt vmcnt(10)
    v_mov_b32 v4, 163080
    v_mov_b32 v5, 7
    s_mov_b64 exec, 1
    ds_write_b32 v4, v5
    s_mov_b64 exec, -1
    s_mov_b32 s14, 640000
L_ldw_9:
    ds_read_b32 v2, v3
    s_waitcnt lgkmcnt(0)
    v_cmp_gt_u32 vcc, 5, v2
    s_cbranch_vccz L_ldd_10
    s_sub_u32 s14, s14, 1
    s_cmp_lg_u32 s14, 0
    s_cbranch_scc1 L_ldw_9
L_ldd_10:
    s_cmp_ge_u32 s86, 2
    s_cselect_b32 s82, s78, s70
    s_cselect_b32 s83, s79, s71
    s_cselect_b32 s84, s80, s72
    s_cselect_b32 s85, s81, s73
    s_mov_b32 m0, 52224
    s_nop 0
    global_load_lds_dwordx4 v11, s[82:83] offset:1024
    s_mov_b32 m0, 53248
    s_nop 0
    global_load_lds_dwordx4 v11, s[84:85] offset:1024
    s_mov_b32 m0, 54272
    s_nop 0
    global_load_lds_dwordx4 v12, s[82:83] offset:1024
    s_mov_b32 m0, 55296
    s_nop 0
    global_load_lds_dwordx4 v12, s[84:85] offset:1024
    s_mov_b32 m0, 56320
    s_nop 0
    global_load_lds_dwordx4 v13, s[82:83] offset:1024
    s_mov_b32 m0, 57344
    s_nop 0
    global_load_lds_dwordx4 v13, s[84:85] offset:1024
    s_mov_b32 m0, 58368
    s_nop 0
    global_load_lds_dwordx4 v14, s[82:83] offset:1024
    s_mov_b32 m0, 59392
    s_nop 0
    global_load_lds_dwordx4 v14, s[84:85] offset:1024
    s_mov_b32 m0, 60416
    s_nop 0
    global_load_lds_dwordx4 v15, s[82:83] offset:1024
    s_mov_b32 m0, 61440
    s_nop 0
    global_load_lds_dwordx4 v15, s[84:85] offset:1024
    s_waitcnt vmcnt(10)
    v_mov_b32 v4, 163080
    v_mov_b32 v5, 8
    s_mov_b64 exec, 1
    ds_write_b32 v4, v5
    s_mov_b64 exec, -1
    s_mov_b32 s14, 640000
L_ldw_11:
    ds_read_b32 v2, v3
    s_waitcnt lgkmcnt(0)
    v_cmp_gt_u32 vcc, 6, v2
    s_cbranch_vccz L_ldd_12
    s_sub_u32 s14, s14, 1
    s_cmp_lg_u32 s14, 0
    s_cbranch_scc1 L_ldw_11
L_ldd_12:
    s_cmp_ge_u32 s86, 1
    s_cselect_b32 s82, s78, s70
    s_cselect_b32 s83, s79, s71
    s_cselect_b32 s84, s80, s72
    s_cselect_b32 s85, s81, s73
    s_mov_b32 m0, 62336
    s_nop 0
    global_load_lds_dwordx4 v11, s[82:83] offset:1152
    s_mov_b32 m0, 63360
    s_nop 0
    global_load_lds_dwordx4 v11, s[84:85] offset:1152
    s_mov_b32 m0, 64384
    s_nop 0
    global_load_lds_dwordx4 v12, s[82:83] offset:1152
    s_mov_b32 m0, 65408
    s_nop 0
    global_load_lds_dwordx4 v12, s[84:85] offset:1152
    s_mov_b32 m0, 66432
    s_nop 0
    global_load_lds_dwordx4 v13, s[82:83] offset:1152
    s_mov_b32 m0, 67456
    s_nop 0
    global_load_lds_dwordx4 v13, s[84:85] offset:1152
    s_mov_b32 m0, 68480
    s_nop 0
    global_load_lds_dwordx4 v14, s[82:83] offset:1152
    s_mov_b32 m0, 69504
    s_nop 0
    global_load_lds_dwordx4 v14, s[84:85] offset:1152
    s_mov_b32 m0, 70528
    s_nop 0
    global_load_lds_dwordx4 v15, s[82:83] offset:1152
    s_mov_b32 m0, 71552
    s_nop 0
    global_load_lds_dwordx4 v15, s[84:85] offset:1152
    s_waitcnt vmcnt(10)
    v_mov_b32 v4, 163080
    v_mov_b32 v5, 9
    s_mov_b64 exec, 1
    ds_write_b32 v4, v5
    s_mov_b64 exec, -1
    s_waitcnt vmcnt(0)
    v_mov_b32 v4, 163080
    v_mov_b32 v5, 10
    s_mov_b64 exec, 1
    ds_write_b32 v4, v5
    s_mov_b64 exec, -1
    v_mov_b32 v4, 163084
    v_mov_b32 v5, 1
    s_mov_b64 exec, 1
    ds_write_b32 v4, v5
    s_mov_b64 exec, -1
    s_and_b32 s10, s2, 7
    s_lshl_b32 s10, s10, 7
    s_add_u32 s12, s58, s10
    s_addc_u32 s13, s59, 0
    s_load_dwordx16 s[32:47], s[12:13], 24576 glc
    s_mov_b32 s10, s88
    s_mov_b32 s11, s88
    s_waitcnt lgkmcnt(0)
    s_xor_b64 s[32:33], s[32:33], s[10:11]
    s_xor_b64 s[34:35], s[34:35], s[10:11]
    s_xor_b64 s[36:37], s[36:37], s[10:11]
    s_xor_b64 s[38:39], s[38:39], s[10:11]
    s_xor_b64 s[40:41], s[40:41], s[10:11]
    s_xor_b64 s[42:43], s[42:43], s[10:11]
    s_xor_b64 s[44:45], s[44:45], s[10:11]
    s_xor_b64 s[46:47], s[46:47], s[10:11]
    s_or_b64 s[32:33], s[32:33], s[34:35]
    s_or_b64 s[32:33], s[32:33], s[36:37]
    s_or_b64 s[32:33], s[32:33], s[38:39]
    s_or_b64 s[32:33], s[32:33], s[40:41]
    s_or_b64 s[32:33], s[32:33], s[42:43]
    s_or_b64 s[32:33], s[32:33], s[44:45]
    s_or_b64 s[32:33], s[32:33], s[46:47]
    s_or_b32 s15, s32, s33
    s_load_dwordx16 s[32:47], s[12:13], 24640 glc
    s_waitcnt lgkmcnt(0)
    s_xor_b64 s[32:33], s[32:33], s[10:11]
    s_xor_b64 s[34:35], s[34:35], s[10:11]
    s_xor_b64 s[36:37], s[36:37], s[10:11]
    s_xor_b64 s[38:39], s[38:39], s[10:11]
    s_xor_b64 s[40:41], s[40:41], s[10:11]
    s_xor_b64 s[42:43], s[42:43], s[10:11]
    s_xor_b64 s[44:45], s[44:45], s[10:11]
    s_xor_b64 s[46:47], s[46:47], s[10:11]
    s_or_b64 s[32:33], s[32:33], s[34:35]
    s_or_b64 s[32:33], s[32:33], s[36:37]
    s_or_b64 s[32:33], s[32:33], s[38:39]
    s_or_b64 s[32:33], s[32:33], s[40:41]
    s_or_b64 s[32:33], s[32:33], s[42:43]
    s_or_b64 s[32:33], s[32:33], s[44:45]
    s_or_b64 s[32:33], s[32:33], s[46:47]
    s_or_b32 s15, s15, s32
    s_or_b32 s15, s15, s33
    s_cmp_eq_u32 s15, 0
    s_cselect_b32 s15, 1, 2
    v_mov_b32 v4, 163124
    v_mov_b32 v5, s15
    s_mov_b64 exec, 1
    ds_write_b32 v4, v5
    s_mov_b64 exec, -1
    v_lshlrev_b32 v2, 4, v0
    s_mov_b32 s14, 40000
L_gp_13:
    s_mov_b32 s9, 32768
    buffer_load_dwordx4 v[16:19], v2, s[60:63], s9 offen sc1
    s_add_u32 s9, s9, 1024
    buffer_load_dwordx4 v[20:23], v2, s[60:63], s9 offen sc1
    s_add_u32 s9, s9, 1024
    buffer_load_dwordx4 v[24:27], v2, s[60:63], s9 offen sc1
    s_add_u32 s9, s9, 1024
    buffer_load_dwordx4 v[28:31], v2, s[60:63], s9 offen sc1
    s_add_u32 s9, s9, 1024
    buffer_load_dwordx4 v[32:35], v2, s[60:63], s9 offen sc1
    s_add_u32 s9, s9, 1024
    buffer_load_dwordx4 v[36:39], v2, s[60:63], s9 offen sc1
    s_add_u32 s9, s9, 1024
    buffer_load_dwordx4 v[40:43], v2, s[60:63], s9 offen sc1
    s_add_u32 s9, s9, 1024
    buffer_load_dwordx4 v[44:47], v2, s[60:63], s9 offen sc1
    s_add_u32 s9, s9, 1024
    buffer_load_dwordx4 v[48:51], v2, s[60:63], s9 offen sc1
    s_add_u32 s9, s9, 1024
    buffer_load_dwordx4 v[52:55], v2, s[60:63], s9 offen sc1
    s_add_u32 s9, s9, 1024
    buffer_load_dwordx4 v[56:59], v2, s[60:63], s9 offen sc1
    s_add_u32 s9, s9, 1024
    buffer_load_dwordx4 v[60:63], v2, s[60:63], s9 offen sc1
    s_add_u32 s9, s9, 1024
    buffer_load_dwordx4 v[64:67], v2, s[60:63], s9 offen sc1
    s_add_u32 s9, s9, 1024
    buffer_load_dwordx4 v[68:71], v2, s[60:63], s9 offen sc1
    s_add_u32 s9, s9, 1024
    buffer_load_dwordx4 v[72:75], v2, s[60:63], s9 offen sc1
    s_add_u32 s9, s9, 1024
    buffer_load_dwordx4 v[76:79], v2, s[60:63], s9 offen sc1
    s_waitcnt vmcnt(0)
    s_mov_b64 s[10:11], 0
    v_cmp_ne_u32 vcc, s8, v17
    s_or_b64 s[10:11], s[10:11], vcc
    v_cmp_ne_u32 vcc, s8, v19
    s_or_b64 s[10:11], s[10:11], vcc
    v_cmp_ne_u32 vcc, s8, v21
    s_or_b64 s[10:11], s[10:11], vcc
    v_cmp_ne_u32 vcc, s8, v23
    s_or_b64 s[10:11], s[10:11], vcc
    v_cmp_ne_u32 vcc, s8, v25
    s_or_b64 s[10:11], s[10:11], vcc
    v_cmp_ne_u32 vcc, s8, v27
    s_or_b64 s[10:11], s[10:11], vcc
    v_cmp_ne_u32 vcc, s8, v29
    s_or_b64 s[10:11], s[10:11], vcc
    v_cmp_ne_u32 vcc, s8, v31
    s_or_b64 s[10:11], s[10:11], vcc
    v_cmp_ne_u32 vcc, s8, v33
    s_or_b64 s[10:11], s[10:11], vcc
    v_cmp_ne_u32 vcc, s8, v35
    s_or_b64 s[10:11], s[10:11], vcc
    v_cmp_ne_u32 vcc, s8, v37
    s_or_b64 s[10:11], s[10:11], vcc
    v_cmp_ne_u32 vcc, s8, v39
    s_or_b64 s[10:11], s[10:11], vcc
    v_cmp_ne_u32 vcc, s8, v41
    s_or_b64 s[10:11], s[10:11], vcc
    v_cmp_ne_u32 vcc, s8, v43
    s_or_b64 s[10:11], s[10:11], vcc
    v_cmp_ne_u32 vcc, s8, v45
    s_or_b64 s[10:11], s[10:11], vcc
    v_cmp_ne_u32 vcc, s8, v47
    s_or_b64 s[10:11], s[10:11], vcc
    v_cmp_ne_u32 vcc, s8, v49
    s_or_b64 s[10:11], s[10:11], vcc
    v_cmp_ne_u32 vcc, s8, v51
    s_or_b64 s[10:11], s[10:11], vcc
    v_cmp_ne_u32 vcc, s8, v53
    s_or_b64 s[10:11], s[10:11], vcc
    v_cmp_ne_u32 vcc, s8, v55
    s_or_b64 s[10:11], s[10:11], vcc
    v_cmp_ne_u32 vcc, s8, v57
    s_or_b64 s[10:11], s[10:11], vcc
    v_cmp_ne_u32 vcc, s8, v59
    s_or_b64 s[10:11], s[10:11], vcc
    v_cmp_ne_u32 vcc, s8, v61
    s_or_b64 s[10:11], s[10:11], vcc
    v_cmp_ne_u32 vcc, s8, v63
    s_or_b64 s[10:11], s[10:11], vcc
    v_cmp_ne_u32 vcc, s8, v65
    s_or_b64 s[10:11], s[10:11], vcc
    v_cmp_ne_u32 vcc, s8, v67
    s_or_b64 s[10:11], s[10:11], vcc
    v_cmp_ne_u32 vcc, s8, v69
    s_or_b64 s[10:11], s[10:11], vcc
    v_cmp_ne_u32 vcc, s8, v71
    s_or_b64 s[10:11], s[10:11], vcc
    v_cmp_ne_u32 vcc, s8, v73
    s_or_b64 s[10:11], s[10:11], vcc
    v_cmp_ne_u32 vcc, s8, v75
    s_or_b64 s[10:11], s[10:11], vcc
    v_cmp_ne_u32 vcc, s8, v77
    s_or_b64 s[10:11], s[10:11], vcc
    v_cmp_ne_u32 vcc, s8, v79
    s_or_b64 s[10:11], s[10:11], vcc
    s_cmp_eq_u64 s[10:11], 0
    s_cbranch_scc1 L_gd_14
    s_sleep 4
    s_sub_u32 s14, s14, 4
    s_cmp_gt_i32 s14, 0
    s_cbranch_scc1 L_gp_13
L_gd_14:
    v_lshlrev_b32 v3, 2, v0
    v_add_u32 v3, 0, v3
    v_lshrrev_b32 v16, 16, v16
    v_and_b32 v18, 0xffff0000, v18
    v_or_b32 v16, v16, v18
    ds_write_b32 v3, v16 offset:0
    v_lshrrev_b32 v20, 16, v20
    v_and_b32 v22, 0xffff0000, v22
    v_or_b32 v20, v20, v22
    ds_write_b32 v3, v20 offset:256
    v_lshrrev_b32 v24, 16, v24
    v_and_b32 v26, 0xffff0000, v26
    v_or_b32 v24, v24, v26
    ds_write_b32 v3, v24 offset:512
    v_lshrrev_b32 v28, 16, v28
    v_and_b32 v30, 0xffff0000, v30
    v_or_b32 v28, v28, v30
    ds_write_b32 v3, v28 offset:768
    v_lshrrev_b32 v32, 16, v32
    v_and_b32 v34, 0xffff0000, v34
    v_or_b32 v32, v32, v34
    ds_write_b32 v3, v32 offset:1024
    v_lshrrev_b32 v36, 16, v36
    v_and_b32 v38, 0xffff0000, v38
    v_or_b32 v36, v36, v38
    ds_write_b32 v3, v36 offset:1280
    v_lshrrev_b32 v40, 16, v40
    v_and_b32 v42, 0xffff0000, v42
    v_or_b32 v40, v40, v42
    ds_write_b32 v3, v40 offset:1536
    v_lshrrev_b32 v44, 16, v44
    v_and_b32 v46, 0xffff0000, v46
    v_or_b32 v44, v44, v46
    ds_write_b32 v3, v44 offset:1792
    v_lshrrev_b32 v48, 16, v48
    v_and_b32 v50, 0xffff0000, v50
    v_or_b32 v48, v48, v50
    ds_write_b32 v3, v48 offset:2048
    v_lshrrev_b32 v52, 16, v52
    v_and_b32 v54, 0xffff0000, v54
    v_or_b32 v52, v52, v54
    ds_write_b32 v3, v52 offset:2304
    v_lshrrev_b32 v56, 16, v56
    v_and_b32 v58, 0xffff0000, v58
    v_or_b32 v56, v56, v58
    ds_write_b32 v3, v56 offset:2560
    v_lshrrev_b32 v60, 16, v60
    v_and_b32 v62, 0xffff0000, v62
    v_or_b32 v60, v60, v62
    ds_write_b32 v3, v60 offset:2816
    v_lshrrev_b32 v64, 16, v64
    v_and_b32 v66, 0xffff0000, v66
    v_or_b32 v64, v64, v66
    ds_write_b32 v3, v64 offset:3072
    v_lshrrev_b32 v68, 16, v68
    v_and_b32 v70, 0xffff0000, v70
    v_or_b32 v68, v68, v70
    ds_write_b32 v3, v68 offset:3328
    v_lshrrev_b32 v72, 16, v72
    v_and_b32 v74, 0xffff0000, v74
    v_or_b32 v72, v72, v74
    ds_write_b32 v3, v72 offset:3584
    v_lshrrev_b32 v76, 16, v76
    v_and_b32 v78, 0xffff0000, v78
    v_or_b32 v76, v76, v78
    ds_write_b32 v3, v76 offset:3840
    s_waitcnt lgkmcnt(0)
    v_mov_b32 v4, 163072
    v_mov_b32 v5, 1
    s_mov_b64 exec, 1
    ds_write_b32 v4, v5
    s_mov_b64 exec, -1
    s_mul_i32 s9, s7, 320
    s_add_u32 s9, s9, 16384
    s_add_u32 s12, s58, s9
    s_addc_u32 s13, s59, 0
    s_mov_b32 s10, s8
    s_mov_b32 s11, s8
    s_mov_b32 s14, 40000
L_pr_15:
    s_mov_b32 s15, 0
    s_load_dwordx16 s[16:31], s[12:13], 0 glc
    s_load_dwordx16 s[32:47], s[12:13], 64 glc
    s_waitcnt lgkmcnt(0)
    s_xor_b64 s[16:17], s[16:17], s[10:11]
    s_xor_b64 s[18:19], s[18:19], s[10:11]
    s_xor_b64 s[20:21], s[20:21], s[10:11]
    s_xor_b64 s[22:23], s[22:23], s[10:11]
    s_xor_b64 s[24:25], s[24:25], s[10:11]
    s_xor_b64 s[26:27], s[26:27], s[10:11]
    s_xor_b64 s[28:29], s[28:29], s[10:11]
    s_xor_b64 s[30:31], s[30:31], s[10:11]
    s_xor_b64 s[32:33], s[32:33], s[10:11]
    s_xor_b64 s[34:35], s[34:35], s[10:11]
    s_xor_b64 s[36:37], s[36:37], s[10:11]
    s_xor_b64 s[38:39], s[38:39], s[10:11]
    s_xor_b64 s[40:41], s[40:41], s[10:11]
    s_xor_b64 s[42:43], s[42:43], s[10:11]
    s_xor_b64 s[44:45], s[44:45], s[10:11]
    s_xor_b64 s[46:47], s[46:47], s[10:11]
    s_or_b64 s[16:17], s[16:17], s[18:19]
    s_or_b64 s[16:17], s[16:17], s[20:21]
    s_or_b64 s[16:17], s[16:17], s[22:23]
    s_or_b64 s[16:17], s[16:17], s[24:25]
    s_or_b64 s[16:17], s[16:17], s[26:27]
    s_or_b64 s[16:17], s[16:17], s[28:29]
    s_or_b64 s[16:17], s[16:17], s[30:31]
    s_or_b64 s[16:17], s[16:17], s[32:33]
    s_or_b64 s[16:17], s[16:17], s[34:35]
    s_or_b64 s[16:17], s[16:17], s[36:37]
    s_or_b64 s[16:17], s[16:17], s[38:39]
    s_or_b64 s[16:17], s[16:17], s[40:41]
    s_or_b64 s[16:17], s[16:17], s[42:43]
    s_or_b64 s[16:17], s[16:17], s[44:45]
    s_or_b64 s[16:17], s[16:17], s[46:47]
    s_or_b32 s15, s15, s16
    s_or_b32 s15, s15, s17
    s_load_dwordx16 s[16:31], s[12:13], 128 glc
    s_load_dwordx16 s[32:47], s[12:13], 192 glc
    s_waitcnt lgkmcnt(0)
    s_xor_b64 s[16:17], s[16:17], s[10:11]
    s_xor_b64 s[18:19], s[18:19], s[10:11]
    s_xor_b64 s[20:21], s[20:21], s[10:11]
    s_xor_b64 s[22:23], s[22:23], s[10:11]
    s_xor_b64 s[24:25], s[24:25], s[10:11]
    s_xor_b64 s[26:27], s[26:27], s[10:11]
    s_xor_b64 s[28:29], s[28:29], s[10:11]
    s_xor_b64 s[30:31], s[30:31], s[10:11]
    s_xor_b64 s[32:33], s[32:33], s[10:11]
    s_xor_b64 s[34:35], s[34:35], s[10:11]
    s_xor_b64 s[36:37], s[36:37], s[10:11]
    s_xor_b64 s[38:39], s[38:39], s[10:11]
    s_xor_b64 s[40:41], s[40:41], s[10:11]
    s_xor_b64 s[42:43], s[42:43], s[10:11]
    s_xor_b64 s[44:45], s[44:45], s[10:11]
    s_xor_b64 s[46:47], s[46:47], s[10:11]
    s_or_b64 s[16:17], s[16:17], s[18:19]
    s_or_b64 s[16:17], s[16:17], s[20:21]
    s_or_b64 s[16:17], s[16:17], s[22:23]
    s_or_b64 s[16:17], s[16:17], s[24:25]
    s_or_b64 s[16:17], s[16:17], s[26:27]
    s_or_b64 s[16:17], s[16:17], s[28:29]
    s_or_b64 s[16:17], s[16:17], s[30:31]
    s_or_b64 s[16:17], s[16:17], s[32:33]
    s_or_b64 s[16:17], s[16:17], s[34:35]
    s_or_b64 s[16:17], s[16:17], s[36:37]
    s_or_b64 s[16:17], s[16:17], s[38:39]
    s_or_b64 s[16:17], s[16:17], s[40:41]
    s_or_b64 s[16:17], s[16:17], s[42:43]
    s_or_b64 s[16:17], s[16:17], s[44:45]
    s_or_b64 s[16:17], s[16:17], s[46:47]
    s_or_b32 s15, s15, s16
    s_or_b32 s15, s15, s17
    s_load_dwordx16 s[16:31], s[12:13], 256 glc
    s_waitcnt lgkmcnt(0)
    s_xor_b64 s[16:17], s[16:17], s[10:11]
    s_xor_b64 s[18:19], s[18:19], s[10:11]
    s_xor_b64 s[20:21], s[20:21], s[10:11]
    s_xor_b64 s[22:23], s[22:23], s[10:11]
    s_xor_b64 s[24:25], s[24:25], s[10:11]
    s_xor_b64 s[26:27], s[26:27], s[10:11]
    s_xor_b64 s[28:29], s[28:29], s[10:11]
    s_xor_b64 s[30:31], s[30:31], s[10:11]
    s_or_b64 s[16:17], s[16:17], s[18:19]
    s_or_b64 s[16:17], s[16:17], s[20:21]
    s_or_b64 s[16:17], s[16:17], s[22:23]
    s_or_b64 s[16:17], s[16:17], s[24:25]
    s_or_b64 s[16:17], s[16:17], s[26:27]
    s_or_b64 s[16:17], s[16:17], s[28:29]
    s_or_b64 s[16:17], s[16:17], s[30:31]
    s_or_b32 s15, s15, s16
    s_or_b32 s15, s15, s17
    s_cmp_eq_u32 s15, 0
    s_cbranch_scc1 L_prd_16
    s_sleep 4
    s_sub_u32 s14, s14, 1
    s_cmp_lg_u32 s14, 0
    s_cbranch_scc1 L_pr_15
L_prd_16:
    s_mul_i32 s9, s7, 327680
    s_lshl_b32 s10, s6, 7
    s_add_u32 s9, s9, s10
    s_add_u32 s9, s9, 4194304
    v_lshrrev_b32 v2, 3, v0
    v_and_b32 v3, 7, v0
    v_lshlrev_b32 v3, 4, v3
    v_lshlrev_b32 v4, 12, v2
    v_add_u32 v4, v4, v3
    v_mul_u32_u24 v5, 144, v2
    v_add_u32 v5, v5, v3
    v_add_u32 v5, 151552, v5
    buffer_load_dwordx4 v[16:19], v4, s[60:63], s9 offen sc1
    s_add_u32 s9, s9, 32768
    buffer_load_dwordx4 v[20:23], v4, s[60:63], s9 offen sc1
    s_add_u32 s9, s9, 32768
    buffer_load_dwordx4 v[24:27], v4, s[60:63], s9 offen sc1
    s_add_u32 s9, s9, 32768
    buffer_load_dwordx4 v[28:31], v4, s[60:63], s9 offen sc1
    s_add_u32 s9, s9, 32768
    buffer_load_dwordx4 v[32:35], v4, s[60:63], s9 offen sc1
    s_add_u32 s9, s9, 32768
    buffer_load_dwordx4 v[36:39], v4, s[60:63], s9 offen sc1
    s_add_u32 s9, s9, 32768
    buffer_load_dwordx4 v[40:43], v4, s[60:63], s9 offen sc1
    s_add_u32 s9, s9, 32768
    buffer_load_dwordx4 v[44:47], v4, s[60:63], s9 offen sc1
    s_add_u32 s9, s9, 32768
    buffer_load_dwordx4 v[48:51], v4, s[60:63], s9 offen sc1
    s_add_u32 s9, s9, 32768
    buffer_load_dwordx4 v[52:55], v4, s[60:63], s9 offen sc1
    s_waitcnt vmcnt(9)
    ds_write_b128 v5, v[16:19] offset:0
    s_waitcnt vmcnt(8)
    ds_write_b128 v5, v[20:23] offset:1152
    s_waitcnt vmcnt(7)
    ds_write_b128 v5, v[24:27] offset:2304
    s_waitcnt vmcnt(6)
    ds_write_b128 v5, v[28:31] offset:3456
    s_waitcnt vmcnt(5)
    ds_write_b128 v5, v[32:35] offset:4608
    s_waitcnt vmcnt(4)
    ds_write_b128 v5, v[36:39] offset:5760
    s_waitcnt vmcnt(3)
    ds_write_b128 v5, v[40:43] offset:6912
    s_waitcnt vmcnt(2)
    ds_write_b128 v5, v[44:47] offset:8064
    s_waitcnt vmcnt(1)
    ds_write_b128 v5, v[48:51] offset:9216
    s_waitcnt vmcnt(0)
    ds_write_b128 v5, v[52:55] offset:10368
    s_waitcnt lgkmcnt(0)
    v_mov_b32 v4, 163076
    v_mov_b32 v5, 1
    s_mov_b64 exec, 1
    ds_write_b32 v4, v5
    s_mov_b64 exec, -1
    s_branch L_exit
L_s4:
    s_sub_u32 s9, s3, 4
    s_cmp_lt_u32 s2, 128
    s_cbranch_scc1 L_s4_lo
    s_cmp_ge_u32 s9, 2
    s_cbranch_scc1 L_exit
    s_lshl_b32 s68, s2, 1
    s_add_u32 s68, s68, 128
    s_add_u32 s68, s68, s9
    s_branch L_s4_go
L_s4_lo:
    s_mul_i32 s68, s2, 3
    s_add_u32 s68, s68, s9
L_s4_go:
    s_lshl_b32 s69, s9, 14
    s_add_u32 s69, s69, 102400
    s_lshl_b32 s10, s68, 8
    v_lshlrev_b32 v1, 2, v0
    v_add_u32 v1, s10, v1
    global_load_dword v2, v1, s[36:37]
    global_load_dword v3, v1, s[38:39]
    global_load_dword v4, v1, s[40:41]
    global_load_dword v5, v1, s[42:43]
    global_load_dword v6, v1, s[44:45]
    global_load_dword v7, v1, s[46:47]
    s_waitcnt lgkmcnt(0)
    s_barrier
    s_lshr_b32 s10, s68, 1
    s_lshl_b32 s10, s10, 2
    s_load_dword s70, s[48:49], s10
    s_load_dword s71, s[32:33], s10
    s_load_dword s72, s[50:51], s10
    v_lshlrev_b32 v24, 2, v0
    v_add_u32 v24, s69, v24
    v_xor_b32 v8, 0, v24
    v_xor_b32 v9, 16, v24
    v_xor_b32 v10, 32, v24
    v_xor_b32 v11, 48, v24
    v_xor_b32 v12, 64, v24
    v_xor_b32 v13, 80, v24
    v_xor_b32 v14, 96, v24
    v_xor_b32 v15, 112, v24
    v_xor_b32 v16, 128, v24
    v_xor_b32 v17, 144, v24
    v_xor_b32 v18, 160, v24
    v_xor_b32 v19, 176, v24
    v_xor_b32 v20, 192, v24
    v_xor_b32 v21, 208, v24
    v_xor_b32 v22, 224, v24
    v_xor_b32 v23, 240, v24
    v_and_b32 v28, 15, v0
    v_lshrrev_b32 v29, 4, v0
    v_xor_b32 v29, v29, v28
    v_lshlrev_b32 v29, 4, v29
    v_lshlrev_b32 v28, 8, v28
    v_add_u32 v28, s69, v28
    v_xor_b32 v30, 0, v29
    v_add_u32 v24, v28, v30
    v_xor_b32 v30, 64, v29
    v_add_u32 v25, v28, v30
    v_xor_b32 v30, 128, v29
    v_add_u32 v26, v28, v30
    v_xor_b32 v30, 192, v29
    v_add_u32 v27, v28, v30
    s_waitcnt lgkmcnt(0)
    s_mul_i32 s8, s8, 0x9E3779B1
    s_add_u32 s8, s8, 0x7F4A7C15
    s_and_b32 s10, s68, 1
    s_lshl_b32 s10, s10, 4
    s_lshr_b32 s70, s70, s10
    s_lshl_b32 s70, s70, 16
    s_lshr_b32 s71, s71, s10
    s_lshl_b32 s71, s71, 16
    s_lshr_b32 s72, s72, s10
    s_lshl_b32 s72, s72, 16
    v_mov_b32 v28, s70
    v_mul_f32 v28, 0x3FB8AA3B, v28
    v_exp_f32 v28, v28
    s_nop 0
    v_cvt_pk_bf16_f32 v28, v28, v28
    v_lshlrev_b32 v28, 16, v28
    v_accvgpr_write_b32 a0, 0
    v_accvgpr_write_b32 a1, 0
    v_accvgpr_write_b32 a2, 0
    v_accvgpr_write_b32 a3, 0
    v_accvgpr_write_b32 a4, 0
    v_accvgpr_write_b32 a5, 0
    v_accvgpr_write_b32 a6, 0
    v_accvgpr_write_b32 a7, 0
    v_accvgpr_write_b32 a8, 0
    v_accvgpr_write_b32 a9, 0
    v_accvgpr_write_b32 a10, 0
    v_accvgpr_write_b32 a11, 0
    s_waitcnt vmcnt(0)
    v_lshlrev_b32 v32, 16, v2
    v_lshlrev_b32 v33, 16, v3
    v_lshlrev_b32 v34, 16, v4
    v_lshlrev_b32 v35, 16, v5
    v_lshlrev_b32 v36, 16, v6
    v_lshlrev_b32 v37, 16, v7
    v_mul_f32 v38, v28, v32
    v_mul_f32 v38, 0x3FB8AA3B, v38
    v_mul_f32 v39, v28, v33
    v_mul_f32 v39, 0x3E22F983, v39
    v_mul_f32 v34, v28, v34
    v_mul_f32 v35, v28, v35
    v_pk_mul_f32 v[54:55], v[36:37], v[34:35] op_sel_hi:[0,1]
    v_pk_fma_f32 v[54:55], v[36:37], v[34:35], v[54:55] op_sel:[1,1,0] op_sel_hi:[1,0,1] neg_lo:[1,0,0]
    v_exp_f32 v40, v38
    v_fract_f32 v41, v39
    v_cos_f32 v42, v41
    v_sin_f32 v43, v41
    s_nop 0
    v_mul_f32 v42, v40, v42
    v_mul_f32 v43, v40, v43
    v_mul_f32 v40, 0x41000000, v38
    v_mul_f32 v41, 0x41000000, v39
    v_exp_f32 v40, v40
    v_fract_f32 v41, v41
    v_cos_f32 v44, v41
    v_sin_f32 v45, v41
    s_nop 0
    v_mul_f32 v44, v40, v44
    v_mul_f32_e64 v45, -v40, v45
    v_mul_f32 v40, 0x43000000, v38
    v_mul_f32 v41, 0x43000000, v39
    v_exp_f32 v40, v40
    v_fract_f32 v41, v41
    v_cos_f32 v46, v41
    v_sin_f32 v47, v41
    s_nop 0
    v_mul_f32 v46, v40, v46
    v_mul_f32 v47, v40, v47
    v_pk_mul_f32 v[48:49], v[46:47], v[46:47] op_sel_hi:[0,1]
    v_pk_fma_f32 v[48:49], v[46:47], v[46:47], v[48:49] op_sel:[1,1,0] op_sel_hi:[1,0,1] neg_lo:[1,0,0]
    v_pk_mul_f32 v[50:51], v[48:49], v[48:49] op_sel_hi:[0,1]
    v_pk_fma_f32 v[50:51], v[48:49], v[48:49], v[50:51] op_sel:[1,1,0] op_sel_hi:[1,0,1] neg_lo:[1,0,0]
    v_pk_mul_f32 v[52:53], v[50:51], v[50:51] op_sel_hi:[0,1]
    v_pk_fma_f32 v[52:53], v[50:51], v[50:51], v[52:53] op_sel:[1,1,0] op_sel_hi:[1,0,1] neg_lo:[1,0,0]
    v_mov_b32 v60, v54
    v_mov_b32 v61, v55
    v_pk_mul_f32 v[62:63], v[60:61], v[42:43] op_sel_hi:[0,1]
    v_pk_fma_f32 v[62:63], v[60:61], v[42:43], v[62:63] op_sel:[1,1,0] op_sel_hi:[1,0,1] neg_lo:[1,0,0]
    v_pk_mul_f32 v[64:65], v[62:63], v[42:43] op_sel_hi:[0,1]
    v_pk_fma_f32 v[64:65], v[62:63], v[42:43], v[64:65] op_sel:[1,1,0] op_sel_hi:[1,0,1] neg_lo:[1,0,0]
    v_pk_mul_f32 v[66:67], v[64:65], v[42:43] op_sel_hi:[0,1]
    v_pk_fma_f32 v[66:67], v[64:65], v[42:43], v[66:67] op_sel:[1,1,0] op_sel_hi:[1,0,1] neg_lo:[1,0,0]
    v_pk_mul_f32 v[68:69], v[66:67], v[42:43] op_sel_hi:[0,1]
    v_pk_fma_f32 v[68:69], v[66:67], v[42:43], v[68:69] op_sel:[1,1,0] op_sel_hi:[1,0,1] neg_lo:[1,0,0]
    v_pk_mul_f32 v[70:71], v[68:69], v[42:43] op_sel_hi:[0,1]
    v_pk_fma_f32 v[70:71], v[68:69], v[42:43], v[70:71] op_sel:[1,1,0] op_sel_hi:[1,0,1] neg_lo:[1,0,0]
    v_pk_mul_f32 v[72:73], v[70:71], v[42:43] op_sel_hi:[0,1]
    v_pk_fma_f32 v[72:73], v[70:71], v[42:43], v[72:73] op_sel:[1,1,0] op_sel_hi:[1,0,1] neg_lo:[1,0,0]
    v_pk_mul_f32 v[74:75], v[72:73], v[42:43] op_sel_hi:[0,1]
    v_pk_fma_f32 v[74:75], v[72:73], v[42:43], v[74:75] op_sel:[1,1,0] op_sel_hi:[1,0,1] neg_lo:[1,0,0]
    v_pk_mul_f32 v[76:77], v[60:61], v[46:47] op_sel_hi:[0,1]
    v_pk_fma_f32 v[76:77], v[60:61], v[46:47], v[76:77] op_sel:[1,1,0] op_sel_hi:[1,0,1] neg_lo:[1,0,0]
    v_pk_mul_f32 v[78:79], v[62:63], v[46:47] op_sel_hi:[0,1]
    v_pk_fma_f32 v[78:79], v[62:63], v[46:47], v[78:79] op_sel:[1,1,0] op_sel_hi:[1,0,1] neg_lo:[1,0,0]
    v_pk_mul_f32 v[80:81], v[64:65], v[46:47] op_sel_hi:[0,1]
    v_pk_fma_f32 v[80:81], v[64:65], v[46:47], v[80:81] op_sel:[1,1,0] op_sel_hi:[1,0,1] neg_lo:[1,0,0]
    v_pk_mul_f32 v[82:83], v[66:67], v[46:47] op_sel_hi:[0,1]
    v_pk_fma_f32 v[82:83], v[66:67], v[46:47], v[82:83] op_sel:[1,1,0] op_sel_hi:[1,0,1] neg_lo:[1,0,0]
    v_pk_mul_f32 v[84:85], v[68:69], v[46:47] op_sel_hi:[0,1]
    v_pk_fma_f32 v[84:85], v[68:69], v[46:47], v[84:85] op_sel:[1,1,0] op_sel_hi:[1,0,1] neg_lo:[1,0,0]
    v_pk_mul_f32 v[86:87], v[70:71], v[46:47] op_sel_hi:[0,1]
    v_pk_fma_f32 v[86:87], v[70:71], v[46:47], v[86:87] op_sel:[1,1,0] op_sel_hi:[1,0,1] neg_lo:[1,0,0]
    v_pk_mul_f32 v[88:89], v[72:73], v[46:47] op_sel_hi:[0,1]
    v_pk_fma_f32 v[88:89], v[72:73], v[46:47], v[88:89] op_sel:[1,1,0] op_sel_hi:[1,0,1] neg_lo:[1,0,0]
    v_pk_mul_f32 v[90:91], v[74:75], v[46:47] op_sel_hi:[0,1]
    v_pk_fma_f32 v[90:91], v[74:75], v[46:47], v[90:91] op_sel:[1,1,0] op_sel_hi:[1,0,1] neg_lo:[1,0,0]
    v_pk_mul_f32 v[92:93], v[60:61], v[48:49] op_sel_hi:[0,1]
    v_pk_fma_f32 v[92:93], v[60:61], v[48:49], v[92:93] op_sel:[1,1,0] op_sel_hi:[1,0,1] neg_lo:[1,0,0]
    v_pk_mul_f32 v[94:95], v[64:65], v[48:49] op_sel_hi:[0,1]
    v_pk_fma_f32 v[94:95], v[64:65], v[48:49], v[94:95] op_sel:[1,1,0] op_sel_hi:[1,0,1] neg_lo:[1,0,0]
    v_pk_mul_f32 v[96:97], v[68:69], v[48:49] op_sel_hi:[0,1]
    v_pk_fma_f32 v[96:97], v[68:69], v[48:49], v[96:97] op_sel:[1,1,0] op_sel_hi:[1,0,1] neg_lo:[1,0,0]
    v_pk_mul_f32 v[98:99], v[72:73], v[48:49] op_sel_hi:[0,1]
    v_pk_fma_f32 v[98:99], v[72:73], v[48:49], v[98:99] op_sel:[1,1,0] op_sel_hi:[1,0,1] neg_lo:[1,0,0]
    v_pk_mul_f32 v[100:101], v[92:93], v[46:47] op_sel_hi:[0,1]
    v_pk_fma_f32 v[100:101], v[92:93], v[46:47], v[100:101] op_sel:[1,1,0] op_sel_hi:[1,0,1] neg_lo:[1,0,0]
    v_pk_mul_f32 v[102:103], v[94:95], v[46:47] op_sel_hi:[0,1]
    v_pk_fma_f32 v[102:103], v[94:95], v[46:47], v[102:103] op_sel:[1,1,0] op_sel_hi:[1,0,1] neg_lo:[1,0,0]
    v_pk_mul_f32 v[104:105], v[96:97], v[46:47] op_sel_hi:[0,1]
    v_pk_fma_f32 v[104:105], v[96:97], v[46:47], v[104:105] op_sel:[1,1,0] op_sel_hi:[1,0,1] neg_lo:[1,0,0]
    v_pk_mul_f32 v[106:107], v[98:99], v[46:47] op_sel_hi:[0,1]
    v_pk_fma_f32 v[106:107], v[98:99], v[46:47], v[106:107] op_sel:[1,1,0] op_sel_hi:[1,0,1] neg_lo:[1,0,0]
    v_pk_mul_f32 v[108:109], v[60:61], v[50:51] op_sel_hi:[0,1]
    v_pk_fma_f32 v[108:109], v[60:61], v[50:51], v[108:109] op_sel:[1,1,0] op_sel_hi:[1,0,1] neg_lo:[1,0,0]
    v_pk_mul_f32 v[110:111], v[68:69], v[50:51] op_sel_hi:[0,1]
    v_pk_fma_f32 v[110:111], v[68:69], v[50:51], v[110:111] op_sel:[1,1,0] op_sel_hi:[1,0,1] neg_lo:[1,0,0]
    v_pk_mul_f32 v[112:113], v[108:109], v[46:47] op_sel_hi:[0,1]
    v_pk_fma_f32 v[112:113], v[108:109], v[46:47], v[112:113] op_sel:[1,1,0] op_sel_hi:[1,0,1] neg_lo:[1,0,0]
    v_pk_mul_f32 v[114:115], v[110:111], v[46:47] op_sel_hi:[0,1]
    v_pk_fma_f32 v[114:115], v[110:111], v[46:47], v[114:115] op_sel:[1,1,0] op_sel_hi:[1,0,1] neg_lo:[1,0,0]
    v_pk_mul_f32 v[116:117], v[112:113], v[46:47] op_sel_hi:[0,1]
    v_pk_fma_f32 v[116:117], v[112:113], v[46:47], v[116:117] op_sel:[1,1,0] op_sel_hi:[1,0,1] neg_lo:[1,0,0]
    v_pk_mul_f32 v[118:119], v[114:115], v[46:47] op_sel_hi:[0,1]
    v_pk_fma_f32 v[118:119], v[114:115], v[46:47], v[118:119] op_sel:[1,1,0] op_sel_hi:[1,0,1] neg_lo:[1,0,0]
    v_pk_mul_f32 v[120:121], v[116:117], v[46:47] op_sel_hi:[0,1]
    v_pk_fma_f32 v[120:121], v[116:117], v[46:47], v[120:121] op_sel:[1,1,0] op_sel_hi:[1,0,1] neg_lo:[1,0,0]
    v_pk_mul_f32 v[122:123], v[118:119], v[46:47] op_sel_hi:[0,1]
    v_pk_fma_f32 v[122:123], v[118:119], v[46:47], v[122:123] op_sel:[1,1,0] op_sel_hi:[1,0,1] neg_lo:[1,0,0]
    v_pk_mul_f32 v[124:125], v[60:61], v[52:53] op_sel_hi:[0,1]
    v_pk_fma_f32 v[124:125], v[60:61], v[52:53], v[124:125] op_sel:[1,1,0] op_sel_hi:[1,0,1] neg_lo:[1,0,0]
    v_pk_mul_f32 v[126:127], v[124:125], v[46:47] op_sel_hi:[0,1]
    v_pk_fma_f32 v[126:127], v[124:125], v[46:47], v[126:127] op_sel:[1,1,0] op_sel_hi:[1,0,1] neg_lo:[1,0,0]
    v_pk_mul_f32 v[128:129], v[126:127], v[46:47] op_sel_hi:[0,1]
    v_pk_fma_f32 v[128:129], v[126:127], v[46:47], v[128:129] op_sel:[1,1,0] op_sel_hi:[1,0,1] neg_lo:[1,0,0]
    v_pk_mul_f32 v[130:131], v[128:129], v[46:47] op_sel_hi:[0,1]
    v_pk_fma_f32 v[130:131], v[128:129], v[46:47], v[130:131] op_sel:[1,1,0] op_sel_hi:[1,0,1] neg_lo:[1,0,0]
    v_pk_mul_f32 v[132:133], v[130:131], v[46:47] op_sel_hi:[0,1]
    v_pk_fma_f32 v[132:133], v[130:131], v[46:47], v[132:133] op_sel:[1,1,0] op_sel_hi:[1,0,1] neg_lo:[1,0,0]
    v_pk_mul_f32 v[134:135], v[132:133], v[46:47] op_sel_hi:[0,1]
    v_pk_fma_f32 v[134:135], v[132:133], v[46:47], v[134:135] op_sel:[1,1,0] op_sel_hi:[1,0,1] neg_lo:[1,0,0]
    v_pk_mul_f32 v[136:137], v[134:135], v[46:47] op_sel_hi:[0,1]
    v_pk_fma_f32 v[136:137], v[134:135], v[46:47], v[136:137] op_sel:[1,1,0] op_sel_hi:[1,0,1] neg_lo:[1,0,0]
    v_pk_mul_f32 v[138:139], v[136:137], v[46:47] op_sel_hi:[0,1]
    v_pk_fma_f32 v[138:139], v[136:137], v[46:47], v[138:139] op_sel:[1,1,0] op_sel_hi:[1,0,1] neg_lo:[1,0,0]
    v_pk_mul_f32 v[140:141], v[138:139], v[46:47] op_sel_hi:[0,1]
    v_pk_fma_f32 v[140:141], v[138:139], v[46:47], v[140:141] op_sel:[1,1,0] op_sel_hi:[1,0,1] neg_lo:[1,0,0]
    v_cvt_pk_bf16_f32 v60, v60, v61
    v_cvt_pk_bf16_f32 v62, v62, v63
    v_cvt_pk_bf16_f32 v64, v64, v65
    v_cvt_pk_bf16_f32 v66, v66, v67
    v_cvt_pk_bf16_f32 v68, v68, v69
    v_cvt_pk_bf16_f32 v70, v70, v71
    v_cvt_pk_bf16_f32 v72, v72, v73
    v_cvt_pk_bf16_f32 v74, v74, v75
    v_cvt_pk_bf16_f32 v76, v76, v77
    v_cvt_pk_bf16_f32 v78, v78, v79
    v_cvt_pk_bf16_f32 v80, v80, v81
    v_cvt_pk_bf16_f32 v82, v82, v83
    v_cvt_pk_bf16_f32 v84, v84, v85
    v_cvt_pk_bf16_f32 v86, v86, v87
    v_cvt_pk_bf16_f32 v88, v88, v89
    v_cvt_pk_bf16_f32 v90, v90, v91
    v_cvt_pk_bf16_f32 v92, v92, v93
    v_cvt_pk_bf16_f32 v94, v94, v95
    v_cvt_pk_bf16_f32 v96, v96, v97
    v_cvt_pk_bf16_f32 v98, v98, v99
    v_cvt_pk_bf16_f32 v100, v100, v101
    v_cvt_pk_bf16_f32 v102, v102, v103
    v_cvt_pk_bf16_f32 v104, v104, v105
    v_cvt_pk_bf16_f32 v106, v106, v107
    v_cvt_pk_bf16_f32 v108, v108, v109
    v_cvt_pk_bf16_f32 v110, v110, v111
    v_cvt_pk_bf16_f32 v112, v112, v113
    v_cvt_pk_bf16_f32 v114, v114, v115
    v_cvt_pk_bf16_f32 v116, v116, v117
    v_cvt_pk_bf16_f32 v118, v118, v119
    v_cvt_pk_bf16_f32 v120, v120, v121
    v_cvt_pk_bf16_f32 v122, v122, v123
    v_cvt_pk_bf16_f32 v124, v124, v125
    v_cvt_pk_bf16_f32 v126, v126, v127
    v_cvt_pk_bf16_f32 v128, v128, v129
    v_cvt_pk_bf16_f32 v130, v130, v131
    v_cvt_pk_bf16_f32 v132, v132, v133
    v_cvt_pk_bf16_f32 v134, v134, v135
    v_cvt_pk_bf16_f32 v136, v136, v137
    v_cvt_pk_bf16_f32 v138, v138, v139
    v_cvt_pk_bf16_f32 v140, v140, v141
    v_mov_b32 v61, 0x00003F80
    v_cvt_pk_bf16_f32 v63, v44, v45
    v_pk_mul_f32 v[142:143], v[44:45], v[44:45] op_sel_hi:[0,1]
    v_pk_fma_f32 v[142:143], v[44:45], v[44:45], v[142:143] op_sel:[1,1,0] op_sel_hi:[1,0,1] neg_lo:[1,0,0]
    v_cvt_pk_bf16_f32 v65, v142, v143
    v_pk_mul_f32 v[144:145], v[142:143], v[44:45] op_sel_hi:[0,1]
    v_pk_fma_f32 v[144:145], v[142:143], v[44:45], v[144:145] op_sel:[1,1,0] op_sel_hi:[1,0,1] neg_lo:[1,0,0]
    v_cvt_pk_bf16_f32 v67, v144, v145
    v_pk_mul_f32 v[142:143], v[144:145], v[44:45] op_sel_hi:[0,1]
    v_pk_fma_f32 v[142:143], v[144:145], v[44:45], v[142:143] op_sel:[1,1,0] op_sel_hi:[1,0,1] neg_lo:[1,0,0]
    v_cvt_pk_bf16_f32 v69, v142, v143
    v_pk_mul_f32 v[144:145], v[142:143], v[44:45] op_sel_hi:[0,1]
    v_pk_fma_f32 v[144:145], v[142:143], v[44:45], v[144:145] op_sel:[1,1,0] op_sel_hi:[1,0,1] neg_lo:[1,0,0]
    v_cvt_pk_bf16_f32 v71, v144, v145
    v_pk_mul_f32 v[142:143], v[144:145], v[44:45] op_sel_hi:[0,1]
    v_pk_fma_f32 v[142:143], v[144:145], v[44:45], v[142:143] op_sel:[1,1,0] op_sel_hi:[1,0,1] neg_lo:[1,0,0]
    v_cvt_pk_bf16_f32 v73, v142, v143
    v_pk_mul_f32 v[144:145], v[142:143], v[44:45] op_sel_hi:[0,1]
    v_pk_fma_f32 v[144:145], v[142:143], v[44:45], v[144:145] op_sel:[1,1,0] op_sel_hi:[1,0,1] neg_lo:[1,0,0]
    v_cvt_pk_bf16_f32 v75, v144, v145
    v_pk_mul_f32 v[142:143], v[144:145], v[44:45] op_sel_hi:[0,1]
    v_pk_fma_f32 v[142:143], v[144:145], v[44:45], v[142:143] op_sel:[1,1,0] op_sel_hi:[1,0,1] neg_lo:[1,0,0]
    v_cvt_pk_bf16_f32 v77, v142, v143
    v_pk_mul_f32 v[144:145], v[142:143], v[44:45] op_sel_hi:[0,1]
    v_pk_fma_f32 v[144:145], v[142:143], v[44:45], v[144:145] op_sel:[1,1,0] op_sel_hi:[1,0,1] neg_lo:[1,0,0]
    v_cvt_pk_bf16_f32 v79, v144, v145
    v_pk_mul_f32 v[142:143], v[144:145], v[44:45] op_sel_hi:[0,1]
    v_pk_fma_f32 v[142:143], v[144:145], v[44:45], v[142:143] op_sel:[1,1,0] op_sel_hi:[1,0,1] neg_lo:[1,0,0]
    v_cvt_pk_bf16_f32 v81, v142, v143
    v_pk_mul_f32 v[144:145], v[142:143], v[44:45] op_sel_hi:[0,1]
    v_pk_fma_f32 v[144:145], v[142:143], v[44:45], v[144:145] op_sel:[1,1,0] op_sel_hi:[1,0,1] neg_lo:[1,0,0]
    v_cvt_pk_bf16_f32 v83, v144, v145
    v_pk_mul_f32 v[142:143], v[144:145], v[44:45] op_sel_hi:[0,1]
    v_pk_fma_f32 v[142:143], v[144:145], v[44:45], v[142:143] op_sel:[1,1,0] op_sel_hi:[1,0,1] neg_lo:[1,0,0]
    v_cvt_pk_bf16_f32 v85, v142, v143
    v_pk_mul_f32 v[144:145], v[142:143], v[44:45] op_sel_hi:[0,1]
    v_pk_fma_f32 v[144:145], v[142:143], v[44:45], v[144:145] op_sel:[1,1,0] op_sel_hi:[1,0,1] neg_lo:[1,0,0]
    v_cvt_pk_bf16_f32 v87, v144, v145
    v_pk_mul_f32 v[142:143], v[144:145], v[44:45] op_sel_hi:[0,1]
    v_pk_fma_f32 v[142:143], v[144:145], v[44:45], v[142:143] op_sel:[1,1,0] op_sel_hi:[1,0,1] neg_lo:[1,0,0]
    v_cvt_pk_bf16_f32 v89, v142, v143
    v_pk_mul_f32 v[144:145], v[142:143], v[44:45] op_sel_hi:[0,1]
    v_pk_fma_f32 v[144:145], v[142:143], v[44:45], v[144:145] op_sel:[1,1,0] op_sel_hi:[1,0,1] neg_lo:[1,0,0]
    v_cvt_pk_bf16_f32 v91, v144, v145
    ds_write2st64_b32 v8, v60, v92 offset0:0 offset1:16
    ds_write2st64_b32 v9, v62, v94 offset0:1 offset1:17
    ds_write2st64_b32 v10, v64, v96 offset0:2 offset1:18
    ds_write2st64_b32 v11, v66, v98 offset0:3 offset1:19
    ds_write2st64_b32 v12, v68, v100 offset0:4 offset1:20
    ds_write2st64_b32 v13, v70, v102 offset0:5 offset1:21
    ds_write2st64_b32 v14, v72, v104 offset0:6 offset1:22
    ds_write2st64_b32 v15, v74, v106 offset0:7 offset1:23
    ds_write2st64_b32 v16, v76, v108 offset0:8 offset1:24
    ds_write2st64_b32 v17, v78, v110 offset0:9 offset1:25
    ds_write2st64_b32 v18, v80, v112 offset0:10 offset1:26
    ds_write2st64_b32 v19, v82, v114 offset0:11 offset1:27
    ds_write2st64_b32 v20, v84, v116 offset0:12 offset1:28
    ds_write2st64_b32 v21, v86, v118 offset0:13 offset1:29
    ds_write2st64_b32 v22, v88, v120 offset0:14 offset1:30
    ds_write2st64_b32 v23, v90, v122 offset0:15 offset1:31
    ds_write2st64_b32 v8, v124, v61 offset0:32 offset1:48
    ds_write2st64_b32 v9, v126, v63 offset0:33 offset1:49
    ds_write2st64_b32 v10, v128, v65 offset0:34 offset1:50
    ds_write2st64_b32 v11, v130, v67 offset0:35 offset1:51
    ds_write2st64_b32 v12, v132, v69 offset0:36 offset1:52
    ds_write2st64_b32 v13, v134, v71 offset0:37 offset1:53
    ds_write2st64_b32 v14, v136, v73 offset0:38 offset1:54
    ds_write2st64_b32 v15, v138, v75 offset0:39 offset1:55
    ds_write2st64_b32 v16, v140, v77 offset0:40 offset1:56
    ds_write_b32 v17, v79 offset:14592
    ds_write_b32 v18, v81 offset:14848
    ds_write_b32 v19, v83 offset:15104
    ds_write_b32 v20, v85 offset:15360
    ds_write_b32 v21, v87 offset:15616
    ds_write_b32 v22, v89 offset:15872
    ds_write_b32 v23, v91 offset:16128
    s_waitcnt lgkmcnt(0)
    ds_read_b128 v[60:63], v24 offset:0
    ds_read_b128 v[64:67], v24 offset:4096
    ds_read_b128 v[68:71], v24 offset:8192
    ds_read_b128 v[72:75], v24 offset:12288
    ds_read_b128 v[76:79], v25 offset:0
    ds_read_b128 v[80:83], v25 offset:4096
    ds_read_b128 v[84:87], v25 offset:8192
    ds_read_b128 v[88:91], v25 offset:12288
    ds_read_b128 v[92:95], v26 offset:0
    ds_read_b128 v[96:99], v26 offset:4096
    ds_read_b128 v[100:103], v26 offset:8192
    ds_read_b128 v[104:107], v26 offset:12288
    ds_read_b128 v[108:111], v27 offset:0
    ds_read_b128 v[112:115], v27 offset:4096
    ds_read_b128 v[116:119], v27 offset:8192
    ds_read_b128 v[120:123], v27 offset:12288
    s_waitcnt lgkmcnt(12)
    v_mfma_f32_16x16x32_bf16 a[0:3], v[60:63], v[72:75], a[0:3]
    v_mfma_f32_16x16x32_bf16 a[4:7], v[64:67], v[72:75], a[4:7]
    v_mfma_f32_16x16x32_bf16 a[8:11], v[68:71], v[72:75], a[8:11]
    s_waitcnt lgkmcnt(8)
    v_mfma_f32_16x16x32_bf16 a[0:3], v[76:79], v[88:91], a[0:3]
    v_mfma_f32_16x16x32_bf16 a[4:7], v[80:83], v[88:91], a[4:7]
    v_mfma_f32_16x16x32_bf16 a[8:11], v[84:87], v[88:91], a[8:11]
    s_waitcnt lgkmcnt(4)
    v_mfma_f32_16x16x32_bf16 a[0:3], v[92:95], v[104:107], a[0:3]
    v_mfma_f32_16x16x32_bf16 a[4:7], v[96:99], v[104:107], a[4:7]
    v_mfma_f32_16x16x32_bf16 a[8:11], v[100:103], v[104:107], a[8:11]
    s_waitcnt lgkmcnt(0)
    v_mfma_f32_16x16x32_bf16 a[0:3], v[108:111], v[120:123], a[0:3]
    v_mfma_f32_16x16x32_bf16 a[4:7], v[112:115], v[120:123], a[4:7]
    v_mfma_f32_16x16x32_bf16 a[8:11], v[116:119], v[120:123], a[8:11]
    v_and_b32 v32, 0xffff0000, v2
    v_and_b32 v33, 0xffff0000, v3
    v_and_b32 v34, 0xffff0000, v4
    v_and_b32 v35, 0xffff0000, v5
    v_and_b32 v36, 0xffff0000, v6
    v_and_b32 v37, 0xffff0000, v7
    v_mul_f32 v38, v28, v32
    v_mul_f32 v38, 0x3FB8AA3B, v38
    v_mul_f32 v39, v28, v33
    v_mul_f32 v39, 0x3E22F983, v39
    v_mul_f32 v34, v28, v34
    v_mul_f32 v35, v28, v35
    v_pk_mul_f32 v[54:55], v[36:37], v[34:35] op_sel_hi:[0,1]
    v_pk_fma_f32 v[54:55], v[36:37], v[34:35], v[54:55] op_sel:[1,1,0] op_sel_hi:[1,0,1] neg_lo:[1,0,0]
    v_exp_f32 v40, v38
    v_fract_f32 v41, v39
    v_cos_f32 v42, v41
    v_sin_f32 v43, v41
    s_nop 0
    v_mul_f32 v42, v40, v42
    v_mul_f32 v43, v40, v43
    v_mul_f32 v40, 0x41000000, v38
    v_mul_f32 v41, 0x41000000, v39
    v_exp_f32 v40, v40
    v_fract_f32 v41, v41
    v_cos_f32 v44, v41
    v_sin_f32 v45, v41
    s_nop 0
    v_mul_f32 v44, v40, v44
    v_mul_f32_e64 v45, -v40, v45
    v_mul_f32 v40, 0x43000000, v38
    v_mul_f32 v41, 0x43000000, v39
    v_exp_f32 v40, v40
    v_fract_f32 v41, v41
    v_cos_f32 v46, v41
    v_sin_f32 v47, v41
    s_nop 0
    v_mul_f32 v46, v40, v46
    v_mul_f32 v47, v40, v47
    v_pk_mul_f32 v[48:49], v[46:47], v[46:47] op_sel_hi:[0,1]
    v_pk_fma_f32 v[48:49], v[46:47], v[46:47], v[48:49] op_sel:[1,1,0] op_sel_hi:[1,0,1] neg_lo:[1,0,0]
    v_pk_mul_f32 v[50:51], v[48:49], v[48:49] op_sel_hi:[0,1]
    v_pk_fma_f32 v[50:51], v[48:49], v[48:49], v[50:51] op_sel:[1,1,0] op_sel_hi:[1,0,1] neg_lo:[1,0,0]
    v_pk_mul_f32 v[52:53], v[50:51], v[50:51] op_sel_hi:[0,1]
    v_pk_fma_f32 v[52:53], v[50:51], v[50:51], v[52:53] op_sel:[1,1,0] op_sel_hi:[1,0,1] neg_lo:[1,0,0]
    v_mov_b32 v60, v54
    v_mov_b32 v61, v55
    v_pk_mul_f32 v[62:63], v[60:61], v[42:43] op_sel_hi:[0,1]
    v_pk_fma_f32 v[62:63], v[60:61], v[42:43], v[62:63] op_sel:[1,1,0] op_sel_hi:[1,0,1] neg_lo:[1,0,0]
    v_pk_mul_f32 v[64:65], v[62:63], v[42:43] op_sel_hi:[0,1]
    v_pk_fma_f32 v[64:65], v[62:63], v[42:43], v[64:65] op_sel:[1,1,0] op_sel_hi:[1,0,1] neg_lo:[1,0,0]
    v_pk_mul_f32 v[66:67], v[64:65], v[42:43] op_sel_hi:[0,1]
    v_pk_fma_f32 v[66:67], v[64:65], v[42:43], v[66:67] op_sel:[1,1,0] op_sel_hi:[1,0,1] neg_lo:[1,0,0]
    v_pk_mul_f32 v[68:69], v[66:67], v[42:43] op_sel_hi:[0,1]
    v_pk_fma_f32 v[68:69], v[66:67], v[42:43], v[68:69] op_sel:[1,1,0] op_sel_hi:[1,0,1] neg_lo:[1,0,0]
    v_pk_mul_f32 v[70:71], v[68:69], v[42:43] op_sel_hi:[0,1]
    v_pk_fma_f32 v[70:71], v[68:69], v[42:43], v[70:71] op_sel:[1,1,0] op_sel_hi:[1,0,1] neg_lo:[1,0,0]
    v_pk_mul_f32 v[72:73], v[70:71], v[42:43] op_sel_hi:[0,1]
    v_pk_fma_f32 v[72:73], v[70:71], v[42:43], v[72:73] op_sel:[1,1,0] op_sel_hi:[1,0,1] neg_lo:[1,0,0]
    v_pk_mul_f32 v[74:75], v[72:73], v[42:43] op_sel_hi:[0,1]
    v_pk_fma_f32 v[74:75], v[72:73], v[42:43], v[74:75] op_sel:[1,1,0] op_sel_hi:[1,0,1] neg_lo:[1,0,0]
    v_pk_mul_f32 v[76:77], v[60:61], v[46:47] op_sel_hi:[0,1]
    v_pk_fma_f32 v[76:77], v[60:61], v[46:47], v[76:77] op_sel:[1,1,0] op_sel_hi:[1,0,1] neg_lo:[1,0,0]
    v_pk_mul_f32 v[78:79], v[62:63], v[46:47] op_sel_hi:[0,1]
    v_pk_fma_f32 v[78:79], v[62:63], v[46:47], v[78:79] op_sel:[1,1,0] op_sel_hi:[1,0,1] neg_lo:[1,0,0]
    v_pk_mul_f32 v[80:81], v[64:65], v[46:47] op_sel_hi:[0,1]
    v_pk_fma_f32 v[80:81], v[64:65], v[46:47], v[80:81] op_sel:[1,1,0] op_sel_hi:[1,0,1] neg_lo:[1,0,0]
    v_pk_mul_f32 v[82:83], v[66:67], v[46:47] op_sel_hi:[0,1]
    v_pk_fma_f32 v[82:83], v[66:67], v[46:47], v[82:83] op_sel:[1,1,0] op_sel_hi:[1,0,1] neg_lo:[1,0,0]
    v_pk_mul_f32 v[84:85], v[68:69], v[46:47] op_sel_hi:[0,1]
    v_pk_fma_f32 v[84:85], v[68:69], v[46:47], v[84:85] op_sel:[1,1,0] op_sel_hi:[1,0,1] neg_lo:[1,0,0]
    v_pk_mul_f32 v[86:87], v[70:71], v[46:47] op_sel_hi:[0,1]
    v_pk_fma_f32 v[86:87], v[70:71], v[46:47], v[86:87] op_sel:[1,1,0] op_sel_hi:[1,0,1] neg_lo:[1,0,0]
    v_pk_mul_f32 v[88:89], v[72:73], v[46:47] op_sel_hi:[0,1]
    v_pk_fma_f32 v[88:89], v[72:73], v[46:47], v[88:89] op_sel:[1,1,0] op_sel_hi:[1,0,1] neg_lo:[1,0,0]
    v_pk_mul_f32 v[90:91], v[74:75], v[46:47] op_sel_hi:[0,1]
    v_pk_fma_f32 v[90:91], v[74:75], v[46:47], v[90:91] op_sel:[1,1,0] op_sel_hi:[1,0,1] neg_lo:[1,0,0]
    v_pk_mul_f32 v[92:93], v[60:61], v[48:49] op_sel_hi:[0,1]
    v_pk_fma_f32 v[92:93], v[60:61], v[48:49], v[92:93] op_sel:[1,1,0] op_sel_hi:[1,0,1] neg_lo:[1,0,0]
    v_pk_mul_f32 v[94:95], v[64:65], v[48:49] op_sel_hi:[0,1]
    v_pk_fma_f32 v[94:95], v[64:65], v[48:49], v[94:95] op_sel:[1,1,0] op_sel_hi:[1,0,1] neg_lo:[1,0,0]
    v_pk_mul_f32 v[96:97], v[68:69], v[48:49] op_sel_hi:[0,1]
    v_pk_fma_f32 v[96:97], v[68:69], v[48:49], v[96:97] op_sel:[1,1,0] op_sel_hi:[1,0,1] neg_lo:[1,0,0]
    v_pk_mul_f32 v[98:99], v[72:73], v[48:49] op_sel_hi:[0,1]
    v_pk_fma_f32 v[98:99], v[72:73], v[48:49], v[98:99] op_sel:[1,1,0] op_sel_hi:[1,0,1] neg_lo:[1,0,0]
    v_pk_mul_f32 v[100:101], v[92:93], v[46:47] op_sel_hi:[0,1]
    v_pk_fma_f32 v[100:101], v[92:93], v[46:47], v[100:101] op_sel:[1,1,0] op_sel_hi:[1,0,1] neg_lo:[1,0,0]
    v_pk_mul_f32 v[102:103], v[94:95], v[46:47] op_sel_hi:[0,1]
    v_pk_fma_f32 v[102:103], v[94:95], v[46:47], v[102:103] op_sel:[1,1,0] op_sel_hi:[1,0,1] neg_lo:[1,0,0]
    v_pk_mul_f32 v[104:105], v[96:97], v[46:47] op_sel_hi:[0,1]
    v_pk_fma_f32 v[104:105], v[96:97], v[46:47], v[104:105] op_sel:[1,1,0] op_sel_hi:[1,0,1] neg_lo:[1,0,0]
    v_pk_mul_f32 v[106:107], v[98:99], v[46:47] op_sel_hi:[0,1]
    v_pk_fma_f32 v[106:107], v[98:99], v[46:47], v[106:107] op_sel:[1,1,0] op_sel_hi:[1,0,1] neg_lo:[1,0,0]
    v_pk_mul_f32 v[108:109], v[60:61], v[50:51] op_sel_hi:[0,1]
    v_pk_fma_f32 v[108:109], v[60:61], v[50:51], v[108:109] op_sel:[1,1,0] op_sel_hi:[1,0,1] neg_lo:[1,0,0]
    v_pk_mul_f32 v[110:111], v[68:69], v[50:51] op_sel_hi:[0,1]
    v_pk_fma_f32 v[110:111], v[68:69], v[50:51], v[110:111] op_sel:[1,1,0] op_sel_hi:[1,0,1] neg_lo:[1,0,0]
    v_pk_mul_f32 v[112:113], v[108:109], v[46:47] op_sel_hi:[0,1]
    v_pk_fma_f32 v[112:113], v[108:109], v[46:47], v[112:113] op_sel:[1,1,0] op_sel_hi:[1,0,1] neg_lo:[1,0,0]
    v_pk_mul_f32 v[114:115], v[110:111], v[46:47] op_sel_hi:[0,1]
    v_pk_fma_f32 v[114:115], v[110:111], v[46:47], v[114:115] op_sel:[1,1,0] op_sel_hi:[1,0,1] neg_lo:[1,0,0]
    v_pk_mul_f32 v[116:117], v[112:113], v[46:47] op_sel_hi:[0,1]
    v_pk_fma_f32 v[116:117], v[112:113], v[46:47], v[116:117] op_sel:[1,1,0] op_sel_hi:[1,0,1] neg_lo:[1,0,0]
    v_pk_mul_f32 v[118:119], v[114:115], v[46:47] op_sel_hi:[0,1]
    v_pk_fma_f32 v[118:119], v[114:115], v[46:47], v[118:119] op_sel:[1,1,0] op_sel_hi:[1,0,1] neg_lo:[1,0,0]
    v_pk_mul_f32 v[120:121], v[116:117], v[46:47] op_sel_hi:[0,1]
    v_pk_fma_f32 v[120:121], v[116:117], v[46:47], v[120:121] op_sel:[1,1,0] op_sel_hi:[1,0,1] neg_lo:[1,0,0]
    v_pk_mul_f32 v[122:123], v[118:119], v[46:47] op_sel_hi:[0,1]
    v_pk_fma_f32 v[122:123], v[118:119], v[46:47], v[122:123] op_sel:[1,1,0] op_sel_hi:[1,0,1] neg_lo:[1,0,0]
    v_pk_mul_f32 v[124:125], v[60:61], v[52:53] op_sel_hi:[0,1]
    v_pk_fma_f32 v[124:125], v[60:61], v[52:53], v[124:125] op_sel:[1,1,0] op_sel_hi:[1,0,1] neg_lo:[1,0,0]
    v_pk_mul_f32 v[126:127], v[124:125], v[46:47] op_sel_hi:[0,1]
    v_pk_fma_f32 v[126:127], v[124:125], v[46:47], v[126:127] op_sel:[1,1,0] op_sel_hi:[1,0,1] neg_lo:[1,0,0]
    v_pk_mul_f32 v[128:129], v[126:127], v[46:47] op_sel_hi:[0,1]
    v_pk_fma_f32 v[128:129], v[126:127], v[46:47], v[128:129] op_sel:[1,1,0] op_sel_hi:[1,0,1] neg_lo:[1,0,0]
    v_pk_mul_f32 v[130:131], v[128:129], v[46:47] op_sel_hi:[0,1]
    v_pk_fma_f32 v[130:131], v[128:129], v[46:47], v[130:131] op_sel:[1,1,0] op_sel_hi:[1,0,1] neg_lo:[1,0,0]
    v_pk_mul_f32 v[132:133], v[130:131], v[46:47] op_sel_hi:[0,1]
    v_pk_fma_f32 v[132:133], v[130:131], v[46:47], v[132:133] op_sel:[1,1,0] op_sel_hi:[1,0,1] neg_lo:[1,0,0]
    v_pk_mul_f32 v[134:135], v[132:133], v[46:47] op_sel_hi:[0,1]
    v_pk_fma_f32 v[134:135], v[132:133], v[46:47], v[134:135] op_sel:[1,1,0] op_sel_hi:[1,0,1] neg_lo:[1,0,0]
    v_pk_mul_f32 v[136:137], v[134:135], v[46:47] op_sel_hi:[0,1]
    v_pk_fma_f32 v[136:137], v[134:135], v[46:47], v[136:137] op_sel:[1,1,0] op_sel_hi:[1,0,1] neg_lo:[1,0,0]
    v_pk_mul_f32 v[138:139], v[136:137], v[46:47] op_sel_hi:[0,1]
    v_pk_fma_f32 v[138:139], v[136:137], v[46:47], v[138:139] op_sel:[1,1,0] op_sel_hi:[1,0,1] neg_lo:[1,0,0]
    v_pk_mul_f32 v[140:141], v[138:139], v[46:47] op_sel_hi:[0,1]
    v_pk_fma_f32 v[140:141], v[138:139], v[46:47], v[140:141] op_sel:[1,1,0] op_sel_hi:[1,0,1] neg_lo:[1,0,0]
    v_cvt_pk_bf16_f32 v60, v60, v61
    v_cvt_pk_bf16_f32 v62, v62, v63
    v_cvt_pk_bf16_f32 v64, v64, v65
    v_cvt_pk_bf16_f32 v66, v66, v67
    v_cvt_pk_bf16_f32 v68, v68, v69
    v_cvt_pk_bf16_f32 v70, v70, v71
    v_cvt_pk_bf16_f32 v72, v72, v73
    v_cvt_pk_bf16_f32 v74, v74, v75
    v_cvt_pk_bf16_f32 v76, v76, v77
    v_cvt_pk_bf16_f32 v78, v78, v79
    v_cvt_pk_bf16_f32 v80, v80, v81
    v_cvt_pk_bf16_f32 v82, v82, v83
    v_cvt_pk_bf16_f32 v84, v84, v85
    v_cvt_pk_bf16_f32 v86, v86, v87
    v_cvt_pk_bf16_f32 v88, v88, v89
    v_cvt_pk_bf16_f32 v90, v90, v91
    v_cvt_pk_bf16_f32 v92, v92, v93
    v_cvt_pk_bf16_f32 v94, v94, v95
    v_cvt_pk_bf16_f32 v96, v96, v97
    v_cvt_pk_bf16_f32 v98, v98, v99
    v_cvt_pk_bf16_f32 v100, v100, v101
    v_cvt_pk_bf16_f32 v102, v102, v103
    v_cvt_pk_bf16_f32 v104, v104, v105
    v_cvt_pk_bf16_f32 v106, v106, v107
    v_cvt_pk_bf16_f32 v108, v108, v109
    v_cvt_pk_bf16_f32 v110, v110, v111
    v_cvt_pk_bf16_f32 v112, v112, v113
    v_cvt_pk_bf16_f32 v114, v114, v115
    v_cvt_pk_bf16_f32 v116, v116, v117
    v_cvt_pk_bf16_f32 v118, v118, v119
    v_cvt_pk_bf16_f32 v120, v120, v121
    v_cvt_pk_bf16_f32 v122, v122, v123
    v_cvt_pk_bf16_f32 v124, v124, v125
    v_cvt_pk_bf16_f32 v126, v126, v127
    v_cvt_pk_bf16_f32 v128, v128, v129
    v_cvt_pk_bf16_f32 v130, v130, v131
    v_cvt_pk_bf16_f32 v132, v132, v133
    v_cvt_pk_bf16_f32 v134, v134, v135
    v_cvt_pk_bf16_f32 v136, v136, v137
    v_cvt_pk_bf16_f32 v138, v138, v139
    v_cvt_pk_bf16_f32 v140, v140, v141
    v_mov_b32 v61, 0x00003F80
    v_cvt_pk_bf16_f32 v63, v44, v45
    v_pk_mul_f32 v[142:143], v[44:45], v[44:45] op_sel_hi:[0,1]
    v_pk_fma_f32 v[142:143], v[44:45], v[44:45], v[142:143] op_sel:[1,1,0] op_sel_hi:[1,0,1] neg_lo:[1,0,0]
    v_cvt_pk_bf16_f32 v65, v142, v143
    v_pk_mul_f32 v[144:145], v[142:143], v[44:45] op_sel_hi:[0,1]
    v_pk_fma_f32 v[144:145], v[142:143], v[44:45], v[144:145] op_sel:[1,1,0] op_sel_hi:[1,0,1] neg_lo:[1,0,0]
    v_cvt_pk_bf16_f32 v67, v144, v145
    v_pk_mul_f32 v[142:143], v[144:145], v[44:45] op_sel_hi:[0,1]
    v_pk_fma_f32 v[142:143], v[144:145], v[44:45], v[142:143] op_sel:[1,1,0] op_sel_hi:[1,0,1] neg_lo:[1,0,0]
    v_cvt_pk_bf16_f32 v69, v142, v143
    v_pk_mul_f32 v[144:145], v[142:143], v[44:45] op_sel_hi:[0,1]
    v_pk_fma_f32 v[144:145], v[142:143], v[44:45], v[144:145] op_sel:[1,1,0] op_sel_hi:[1,0,1] neg_lo:[1,0,0]
    v_cvt_pk_bf16_f32 v71, v144, v145
    v_pk_mul_f32 v[142:143], v[144:145], v[44:45] op_sel_hi:[0,1]
    v_pk_fma_f32 v[142:143], v[144:145], v[44:45], v[142:143] op_sel:[1,1,0] op_sel_hi:[1,0,1] neg_lo:[1,0,0]
    v_cvt_pk_bf16_f32 v73, v142, v143
    v_pk_mul_f32 v[144:145], v[142:143], v[44:45] op_sel_hi:[0,1]
    v_pk_fma_f32 v[144:145], v[142:143], v[44:45], v[144:145] op_sel:[1,1,0] op_sel_hi:[1,0,1] neg_lo:[1,0,0]
    v_cvt_pk_bf16_f32 v75, v144, v145
    v_pk_mul_f32 v[142:143], v[144:145], v[44:45] op_sel_hi:[0,1]
    v_pk_fma_f32 v[142:143], v[144:145], v[44:45], v[142:143] op_sel:[1,1,0] op_sel_hi:[1,0,1] neg_lo:[1,0,0]
    v_cvt_pk_bf16_f32 v77, v142, v143
    v_pk_mul_f32 v[144:145], v[142:143], v[44:45] op_sel_hi:[0,1]
    v_pk_fma_f32 v[144:145], v[142:143], v[44:45], v[144:145] op_sel:[1,1,0] op_sel_hi:[1,0,1] neg_lo:[1,0,0]
    v_cvt_pk_bf16_f32 v79, v144, v145
    v_pk_mul_f32 v[142:143], v[144:145], v[44:45] op_sel_hi:[0,1]
    v_pk_fma_f32 v[142:143], v[144:145], v[44:45], v[142:143] op_sel:[1,1,0] op_sel_hi:[1,0,1] neg_lo:[1,0,0]
    v_cvt_pk_bf16_f32 v81, v142, v143
    v_pk_mul_f32 v[144:145], v[142:143], v[44:45] op_sel_hi:[0,1]
    v_pk_fma_f32 v[144:145], v[142:143], v[44:45], v[144:145] op_sel:[1,1,0] op_sel_hi:[1,0,1] neg_lo:[1,0,0]
    v_cvt_pk_bf16_f32 v83, v144, v145
    v_pk_mul_f32 v[142:143], v[144:145], v[44:45] op_sel_hi:[0,1]
    v_pk_fma_f32 v[142:143], v[144:145], v[44:45], v[142:143] op_sel:[1,1,0] op_sel_hi:[1,0,1] neg_lo:[1,0,0]
    v_cvt_pk_bf16_f32 v85, v142, v143
    v_pk_mul_f32 v[144:145], v[142:143], v[44:45] op_sel_hi:[0,1]
    v_pk_fma_f32 v[144:145], v[142:143], v[44:45], v[144:145] op_sel:[1,1,0] op_sel_hi:[1,0,1] neg_lo:[1,0,0]
    v_cvt_pk_bf16_f32 v87, v144, v145
    v_pk_mul_f32 v[142:143], v[144:145], v[44:45] op_sel_hi:[0,1]
    v_pk_fma_f32 v[142:143], v[144:145], v[44:45], v[142:143] op_sel:[1,1,0] op_sel_hi:[1,0,1] neg_lo:[1,0,0]
    v_cvt_pk_bf16_f32 v89, v142, v143
    v_pk_mul_f32 v[144:145], v[142:143], v[44:45] op_sel_hi:[0,1]
    v_pk_fma_f32 v[144:145], v[142:143], v[44:45], v[144:145] op_sel:[1,1,0] op_sel_hi:[1,0,1] neg_lo:[1,0,0]
    v_cvt_pk_bf16_f32 v91, v144, v145
    s_nop 0
    ds_write2st64_b32 v8, v60, v92 offset0:0 offset1:16
    ds_write2st64_b32 v9, v62, v94 offset0:1 offset1:17
    ds_write2st64_b32 v10, v64, v96 offset0:2 offset1:18
    ds_write2st64_b32 v11, v66, v98 offset0:3 offset1:19
    ds_write2st64_b32 v12, v68, v100 offset0:4 offset1:20
    ds_write2st64_b32 v13, v70, v102 offset0:5 offset1:21
    ds_write2st64_b32 v14, v72, v104 offset0:6 offset1:22
    ds_write2st64_b32 v15, v74, v106 offset0:7 offset1:23
    ds_write2st64_b32 v16, v76, v108 offset0:8 offset1:24
    ds_write2st64_b32 v17, v78, v110 offset0:9 offset1:25
    ds_write2st64_b32 v18, v80, v112 offset0:10 offset1:26
    ds_write2st64_b32 v19, v82, v114 offset0:11 offset1:27
    ds_write2st64_b32 v20, v84, v116 offset0:12 offset1:28
    ds_write2st64_b32 v21, v86, v118 offset0:13 offset1:29
    ds_write2st64_b32 v22, v88, v120 offset0:14 offset1:30
    ds_write2st64_b32 v23, v90, v122 offset0:15 offset1:31
    ds_write2st64_b32 v8, v124, v61 offset0:32 offset1:48
    ds_write2st64_b32 v9, v126, v63 offset0:33 offset1:49
    ds_write2st64_b32 v10, v128, v65 offset0:34 offset1:50
    ds_write2st64_b32 v11, v130, v67 offset0:35 offset1:51
    ds_write2st64_b32 v12, v132, v69 offset0:36 offset1:52
    ds_write2st64_b32 v13, v134, v71 offset0:37 offset1:53
    ds_write2st64_b32 v14, v136, v73 offset0:38 offset1:54
    ds_write2st64_b32 v15, v138, v75 offset0:39 offset1:55
    ds_write2st64_b32 v16, v140, v77 offset0:40 offset1:56
    ds_write_b32 v17, v79 offset:14592
    ds_write_b32 v18, v81 offset:14848
    ds_write_b32 v19, v83 offset:15104
    ds_write_b32 v20, v85 offset:15360
    ds_write_b32 v21, v87 offset:15616
    ds_write_b32 v22, v89 offset:15872
    ds_write_b32 v23, v91 offset:16128
    s_waitcnt lgkmcnt(0)
    ds_read_b128 v[60:63], v24 offset:0
    ds_read_b128 v[64:67], v24 offset:4096
    ds_read_b128 v[68:71], v24 offset:8192
    ds_read_b128 v[72:75], v24 offset:12288
    ds_read_b128 v[76:79], v25 offset:0
    ds_read_b128 v[80:83], v25 offset:4096
    ds_read_b128 v[84:87], v25 offset:8192
    ds_read_b128 v[88:91], v25 offset:12288
    ds_read_b128 v[92:95], v26 offset:0
    ds_read_b128 v[96:99], v26 offset:4096
    ds_read_b128 v[100:103], v26 offset:8192
    ds_read_b128 v[104:107], v26 offset:12288
    ds_read_b128 v[108:111], v27 offset:0
    ds_read_b128 v[112:115], v27 offset:4096
    ds_read_b128 v[116:119], v27 offset:8192
    ds_read_b128 v[120:123], v27 offset:12288
    s_waitcnt lgkmcnt(12)
    v_mfma_f32_16x16x32_bf16 a[0:3], v[60:63], v[72:75], a[0:3]
    v_mfma_f32_16x16x32_bf16 a[4:7], v[64:67], v[72:75], a[4:7]
    v_mfma_f32_16x16x32_bf16 a[8:11], v[68:71], v[72:75], a[8:11]
    s_waitcnt lgkmcnt(8)
    v_mfma_f32_16x16x32_bf16 a[0:3], v[76:79], v[88:91], a[0:3]
    v_mfma_f32_16x16x32_bf16 a[4:7], v[80:83], v[88:91], a[4:7]
    v_mfma_f32_16x16x32_bf16 a[8:11], v[84:87], v[88:91], a[8:11]
    s_waitcnt lgkmcnt(4)
    v_mfma_f32_16x16x32_bf16 a[0:3], v[92:95], v[104:107], a[0:3]
    v_mfma_f32_16x16x32_bf16 a[4:7], v[96:99], v[104:107], a[4:7]
    v_mfma_f32_16x16x32_bf16 a[8:11], v[100:103], v[104:107], a[8:11]
    s_waitcnt lgkmcnt(0)
    v_mfma_f32_16x16x32_bf16 a[0:3], v[108:111], v[120:123], a[0:3]
    v_mfma_f32_16x16x32_bf16 a[4:7], v[112:115], v[120:123], a[4:7]
    v_mfma_f32_16x16x32_bf16 a[8:11], v[116:119], v[120:123], a[8:11]
    s_nop 7
    s_nop 1
    v_accvgpr_read_b32 v32, a0
    v_accvgpr_read_b32 v33, a1
    v_accvgpr_read_b32 v34, a2
    v_accvgpr_read_b32 v35, a3
    v_accvgpr_read_b32 v36, a4
    v_accvgpr_read_b32 v37, a5
    v_accvgpr_read_b32 v38, a6
    v_accvgpr_read_b32 v39, a7
    v_accvgpr_read_b32 v40, a8
    v_accvgpr_read_b32 v41, a9
    v_accvgpr_read_b32 v42, a10
    v_accvgpr_read_b32 v43, a11
    v_and_b32 v44, 15, v0
    v_lshrrev_b32 v45, 4, v0
    v_lshrrev_b32 v46, 1, v45
    v_lshlrev_b32 v46, 7, v46
    v_and_b32 v47, 1, v45
    v_lshlrev_b32 v47, 2, v47
    v_add_u32 v46, v46, v47
    v_lshlrev_b32 v47, 3, v44
    v_add_u32 v46, v46, v47
    v_lshlrev_b32 v46, 1, v46
    v_add_u32 v46, s69, v46
    v_cvt_pk_bf16_f32 v48, v32, v33
    v_cvt_pk_bf16_f32 v49, v34, v35
    ds_write_b64 v46, v[48:49] offset:0
    v_lshlrev_b32 v46, 7, v45
    v_lshlrev_b32 v47, 3, v44
    v_add_u32 v47, v46, v47
    v_add_u32 v47, 512, v47
    v_lshlrev_b32 v50, 2, v44
    v_add_u32 v50, v46, v50
    v_add_u32 v50, 512, v50
    v_cmp_gt_u32 vcc, 2, v45
    v_mov_b32 v51, 64
    v_mov_b32 v52, 4
    v_cndmask_b32 v47, v50, v47, vcc
    v_cndmask_b32 v51, v51, v52, vcc
    v_add_u32 v47, s69, v47
    v_add_u32 v51, v47, v51
    v_cvt_pk_bf16_f32 v48, v36, v37
    v_cvt_pk_bf16_f32 v49, v38, v39
    ds_write_b32 v47, v48 offset:0
    ds_write_b32 v51, v49 offset:0
    v_lshlrev_b32 v46, 7, v45
    v_lshlrev_b32 v47, 1, v44
    v_add_u32 v46, v46, v47
    v_add_u32 v46, s69, v46
    v_cvt_pk_bf16_f32 v48, v40, v40
    ds_write_b16 v46, v48 offset:1024
    s_nop 0
    v_cvt_pk_bf16_f32 v48, v41, v41
    ds_write_b16 v46, v48 offset:1056
    s_nop 0
    v_cvt_pk_bf16_f32 v48, v42, v42
    ds_write_b16 v46, v48 offset:1088
    s_nop 0
    v_cvt_pk_bf16_f32 v48, v43, v43
    ds_write_b16 v46, v48 offset:1120
    s_nop 0
    s_waitcnt lgkmcnt(0)
    v_mov_b32 v32, 0
    v_mov_b32 v33, 0
    v_mov_b32 v34, 0
    v_mov_b32 v35, 0
    v_lshlrev_b32 v46, 4, v0
    v_add_u32 v46, s69, v46
    s_mov_b32 exec_lo, 0xffffffff
    s_mov_b32 exec_hi, 0x0
    ds_write_b128 v46, v[32:35] offset:10048
    s_mov_b64 exec, 0xF
    ds_write_b128 v46, v[32:35] offset:1536
    s_mov_b32 exec_lo, 0xffffffff
    s_mov_b32 exec_hi, 0x0
    ds_read_b128 v[36:39], v46 offset:0
    v_lshlrev_b32 v47, 3, v0
    v_add_u32 v47, s69, v47
    ds_read_b64 v[40:41], v47 offset:512
    ds_read_b32 v42, v47 offset:520
    s_mov_b64 exec, -1
    v_lshlrev_b32 v48, 2, v0
    v_add_u32 v48, s69, v48
    ds_read2_b32 v[44:45], v48 offset0:192 offset1:193
    v_add_u32 v49, 256, v48
    ds_read2_b32 v[50:51], v49 offset0:192 offset1:193
    s_mov_b32 s10, 0x01000100
    s_mov_b32 s11, 0x03020302
    s_mov_b32 s12, 0x05040302
    s_mov_b32 s13, 0x05040504
    s_waitcnt lgkmcnt(0)
    s_mov_b32 exec_lo, 0xffffffff
    s_mov_b32 exec_hi, 0x0
    ds_write_b128 v46, v[36:39] offset:1600
    v_perm_b32 v52, v40, v40, s10
    v_perm_b32 v53, v41, v40, s12
    v_perm_b32 v54, v41, v41, s10
    v_perm_b32 v55, v42, v41, s12
    ds_write_b128 v46, v[52:55] offset:2112
    s_mov_b64 exec, -1
    v_perm_b32 v56, v44, v44, s10
    v_mov_b32 v57, v44
    v_perm_b32 v58, v44, v44, s11
    v_perm_b32 v59, v45, v45, s10
    ds_write_b128 v46, v[56:59] offset:2624
    v_perm_b32 v60, v50, v50, s10
    v_mov_b32 v62, v50
    v_perm_b32 v63, v50, v50, s11
    v_perm_b32 v66, v51, v51, s10
    v_mov_b32 v61, v60
    v_mov_b32 v64, v63
    v_mov_b32 v65, v63
    v_mov_b32 v67, v66
    v_lshlrev_b32 v47, 5, v0
    v_add_u32 v47, s69, v47
    ds_write_b128 v47, v[60:63] offset:3648
    ds_write_b128 v47, v[64:67] offset:3664
    s_waitcnt lgkmcnt(0)
    v_lshlrev_b32 v31, 6, v0
    v_add_u32 v31, s69, v31
    ds_read_b128 v[32:35], v31 offset:1600
    ds_read_b128 v[36:39], v31 offset:1616
    ds_read_b128 v[40:43], v31 offset:1632
    ds_read_b128 v[44:47], v31 offset:1648
    ds_read_b32 v48, v31 offset:1664
    s_waitcnt lgkmcnt(0)
    v_alignbit_b32 v52, v33, v32, 16
    v_alignbit_b32 v53, v34, v33, 16
    v_alignbit_b32 v54, v35, v34, 16
    v_alignbit_b32 v55, v36, v35, 16
    v_alignbit_b32 v56, v37, v36, 16
    v_alignbit_b32 v57, v38, v37, 16
    v_alignbit_b32 v58, v39, v38, 16
    v_alignbit_b32 v59, v40, v39, 16
    v_alignbit_b32 v60, v41, v40, 16
    v_alignbit_b32 v61, v42, v41, 16
    v_alignbit_b32 v62, v43, v42, 16
    v_alignbit_b32 v63, v44, v43, 16
    v_alignbit_b32 v64, v45, v44, 16
    v_alignbit_b32 v65, v46, v45, 16
    v_alignbit_b32 v66, v47, v46, 16
    v_alignbit_b32 v67, v48, v47, 16
    ds_write_b128 v31, v[52:55] offset:5888
    ds_write_b128 v31, v[56:59] offset:5904
    ds_write_b128 v31, v[60:63] offset:5920
    ds_write_b128 v31, v[64:67] offset:5936
    v_mov_b32 v32, 0
    v_mov_b32 v33, 0
    v_mov_b32 v34, 0
    v_mov_b32 v35, 0
    v_lshlrev_b32 v30, 4, v0
    v_add_u32 v30, s69, v30
    s_mov_b64 exec, 0xF
    ds_write_b128 v30, v[32:35] offset:5824
    s_mov_b64 exec, 1
    v_mov_b32 v36, s69
    ds_read_u16 v37, v36 offset:1600
    s_waitcnt lgkmcnt(0)
    v_lshlrev_b32 v37, 16, v37
    ds_write_b32 v36, v37 offset:5884
    s_mov_b64 exec, -1
    s_mul_hi_u32 s10, s68, 0x6666667
    s_lshl_b32 s10, s10, 6
    s_add_u32 s10, s10, 4096
    s_mov_b32 s9, s10
    s_add_u32 s12, s58, s9
    s_addc_u32 s13, s59, 0
    s_mov_b32 s10, s8
    s_mov_b32 s11, s8
    s_mov_b32 s14, 40000
L_px_17:
    s_mov_b32 s15, 0
    s_load_dwordx16 s[16:31], s[12:13], 0 glc
    s_waitcnt lgkmcnt(0)
    s_xor_b64 s[16:17], s[16:17], s[10:11]
    s_xor_b64 s[18:19], s[18:19], s[10:11]
    s_xor_b64 s[20:21], s[20:21], s[10:11]
    s_xor_b64 s[22:23], s[22:23], s[10:11]
    s_xor_b64 s[24:25], s[24:25], s[10:11]
    s_xor_b64 s[26:27], s[26:27], s[10:11]
    s_xor_b64 s[28:29], s[28:29], s[10:11]
    s_xor_b64 s[30:31], s[30:31], s[10:11]
    s_or_b64 s[16:17], s[16:17], s[18:19]
    s_or_b64 s[16:17], s[16:17], s[20:21]
    s_or_b64 s[16:17], s[16:17], s[22:23]
    s_or_b64 s[16:17], s[16:17], s[24:25]
    s_or_b64 s[16:17], s[16:17], s[26:27]
    s_or_b64 s[16:17], s[16:17], s[28:29]
    s_or_b64 s[16:17], s[16:17], s[30:31]
    s_or_b32 s15, s15, s16
    s_or_b32 s15, s15, s17
    s_cmp_eq_u32 s15, 0
    s_cbranch_scc1 L_pxd_18
    s_sleep 4
    s_sub_u32 s14, s14, 1
    s_cmp_lg_u32 s14, 0
    s_cbranch_scc1 L_px_17
L_pxd_18:
    v_mov_b32 v32, 163084
    s_mov_b32 s14, 640000
L_w3_19:
    ds_read_b32 v33, v32
    s_waitcnt lgkmcnt(0)
    v_cmp_gt_u32 vcc, 1, v33
    s_cbranch_vccz L_w3d_20
    s_sleep 1
    s_sub_u32 s14, s14, 1
    s_cmp_lg_u32 s14, 0
    s_cbranch_scc1 L_w3_19
L_w3d_20:
    s_lshl_b32 s10, s68, 12
    s_add_u32 s10, s10, 1048576
    v_lshlrev_b32 v30, 4, v0
    buffer_load_dwordx4 v[32:35], v30, s[60:63], s10 offen offset:0 sc1
    buffer_load_dwordx4 v[36:39], v30, s[60:63], s10 offen offset:1024 sc1
    buffer_load_dwordx4 v[40:43], v30, s[60:63], s10 offen offset:2048 sc1
    buffer_load_dwordx4 v[44:47], v30, s[60:63], s10 offen offset:3072 sc1
    v_add_u32 v31, s69, v30
    s_waitcnt vmcnt(3)
    v_alignbit_b32 v48, v35, v35, 16
    v_alignbit_b32 v49, v34, v34, 16
    v_alignbit_b32 v50, v33, v33, 16
    v_alignbit_b32 v51, v32, v32, 16
    ds_write_b128 v31, v[48:51] offset:10560
    s_nop 1
    s_waitcnt vmcnt(2)
    v_alignbit_b32 v48, v39, v39, 16
    v_alignbit_b32 v49, v38, v38, 16
    v_alignbit_b32 v50, v37, v37, 16
    v_alignbit_b32 v51, v36, v36, 16
    ds_write_b128 v31, v[48:51] offset:11584
    s_nop 1
    s_waitcnt vmcnt(1)
    v_alignbit_b32 v48, v43, v43, 16
    v_alignbit_b32 v49, v42, v42, 16
    v_alignbit_b32 v50, v41, v41, 16
    v_alignbit_b32 v51, v40, v40, 16
    ds_write_b128 v31, v[48:51] offset:12608
    s_nop 1
    s_waitcnt vmcnt(0)
    v_alignbit_b32 v48, v47, v47, 16
    v_alignbit_b32 v49, v46, v46, 16
    v_alignbit_b32 v50, v45, v45, 16
    v_alignbit_b32 v51, v44, v44, 16
    ds_write_b128 v31, v[48:51] offset:13632
    s_nop 1
    v_and_b32 v12, 15, v0
    v_lshrrev_b32 v13, 4, v0
    v_lshlrev_b32 v13, 3, v13
    v_sub_u32 v13, v12, v13
    v_add_u32 v13, 9, v13
    v_ashrrev_i32 v13, 1, v13
    v_lshlrev_b32 v13, 2, v13
    v_and_b32 v12, 1, v12
    v_cmp_eq_u32 vcc, 0, v12
    v_mov_b32 v12, 1600
    v_mov_b32 v14, 5888
    v_cndmask_b32 v12, v12, v14, vcc
    v_add_u32 v13, v13, v12
    v_add_u32 v8, s69, v13
    v_add_u32 v9, 1024, v8
    v_add_u32 v10, 2048, v8
    v_add_u32 v11, 3072, v8
    v_and_b32 v12, 15, v0
    v_lshlrev_b32 v12, 5, v12
    v_lshrrev_b32 v13, 4, v0
    v_lshlrev_b32 v13, 4, v13
    v_add_u32 v12, v12, v13
    v_add_u32 v12, 10528, v12
    v_add_u32 v12, s69, v12
    v_accvgpr_write_b32 a0, 0
    v_accvgpr_write_b32 a1, 0
    v_accvgpr_write_b32 a2, 0
    v_accvgpr_write_b32 a3, 0
    v_accvgpr_write_b32 a4, 0
    v_accvgpr_write_b32 a5, 0
    v_accvgpr_write_b32 a6, 0
    v_accvgpr_write_b32 a7, 0
    v_accvgpr_write_b32 a8, 0
    v_accvgpr_write_b32 a9, 0
    v_accvgpr_write_b32 a10, 0
    v_accvgpr_write_b32 a11, 0
    v_accvgpr_write_b32 a12, 0
    v_accvgpr_write_b32 a13, 0
    v_accvgpr_write_b32 a14, 0
    v_accvgpr_write_b32 a15, 0
    v_accvgpr_write_b32 a16, 0
    v_accvgpr_write_b32 a17, 0
    v_accvgpr_write_b32 a18, 0
    v_accvgpr_write_b32 a19, 0
    v_accvgpr_write_b32 a20, 0
    v_accvgpr_write_b32 a21, 0
    v_accvgpr_write_b32 a22, 0
    v_accvgpr_write_b32 a23, 0
    v_accvgpr_write_b32 a24, 0
    v_accvgpr_write_b32 a25, 0
    v_accvgpr_write_b32 a26, 0
    v_accvgpr_write_b32 a27, 0
    v_accvgpr_write_b32 a28, 0
    v_accvgpr_write_b32 a29, 0
    v_accvgpr_write_b32 a30, 0
    v_accvgpr_write_b32 a31, 0
    s_waitcnt lgkmcnt(0)
    ds_read2_b32 v[32:33], v8 offset0:0 offset1:1
    ds_read2_b32 v[34:35], v8 offset0:2 offset1:3
    ds_read2_b32 v[36:37], v8 offset0:128 offset1:129
    ds_read2_b32 v[38:39], v8 offset0:130 offset1:131
    ds_read2_b32 v[40:41], v9 offset0:0 offset1:1
    ds_read2_b32 v[42:43], v9 offset0:2 offset1:3
    ds_read2_b32 v[44:45], v9 offset0:128 offset1:129
    ds_read2_b32 v[46:47], v9 offset0:130 offset1:131
    ds_read2_b32 v[48:49], v10 offset0:0 offset1:1
    ds_read2_b32 v[50:51], v10 offset0:2 offset1:3
    ds_read2_b32 v[52:53], v10 offset0:128 offset1:129
    ds_read2_b32 v[54:55], v10 offset0:130 offset1:131
    ds_read2_b32 v[56:57], v11 offset0:0 offset1:1
    ds_read2_b32 v[58:59], v11 offset0:2 offset1:3
    ds_read2_b32 v[60:61], v11 offset0:128 offset1:129
    ds_read2_b32 v[62:63], v11 offset0:130 offset1:131
    ds_read_b128 v[64:67], v12 offset:0
    ds_read_b128 v[68:71], v12 offset:512
    ds_read_b128 v[72:75], v12 offset:1024
    ds_read_b128 v[76:79], v12 offset:1536
    ds_read_b128 v[80:83], v12 offset:2048
    ds_read_b128 v[84:87], v12 offset:2560
    ds_read_b128 v[88:91], v12 offset:3072
    ds_read_b128 v[92:95], v12 offset:3584
    v_add_u32 v8, 64, v8
    v_add_u32 v9, 64, v9
    v_add_u32 v10, 64, v10
    v_add_u32 v11, 64, v11
    v_subrev_u32 v12, 64, v12
    s_mov_b32 s10, 4
    s_waitcnt lgkmcnt(0)
L_s4_conv:
    v_mfma_f32_16x16x32_bf16 a[0:3], v[32:35], v[64:67], a[0:3]
    ds_read2_b32 v[96:97], v8 offset0:0 offset1:1
    v_mfma_f32_16x16x32_bf16 a[4:7], v[32:35], v[68:71], a[4:7]
    ds_read2_b32 v[98:99], v8 offset0:2 offset1:3
    v_mfma_f32_16x16x32_bf16 a[8:11], v[32:35], v[72:75], a[8:11]
    ds_read2_b32 v[100:101], v8 offset0:128 offset1:129
    v_mfma_f32_16x16x32_bf16 a[12:15], v[32:35], v[76:79], a[12:15]
    ds_read2_b32 v[102:103], v8 offset0:130 offset1:131
    v_mfma_f32_16x16x32_bf16 a[16:19], v[32:35], v[80:83], a[16:19]
    ds_read2_b32 v[104:105], v9 offset0:0 offset1:1
    v_mfma_f32_16x16x32_bf16 a[20:23], v[32:35], v[84:87], a[20:23]
    ds_read2_b32 v[106:107], v9 offset0:2 offset1:3
    v_mfma_f32_16x16x32_bf16 a[24:27], v[32:35], v[88:91], a[24:27]
    ds_read2_b32 v[108:109], v9 offset0:128 offset1:129
    v_mfma_f32_16x16x32_bf16 a[28:31], v[32:35], v[92:95], a[28:31]
    ds_read2_b32 v[110:111], v9 offset0:130 offset1:131
    v_mfma_f32_16x16x32_bf16 a[4:7], v[36:39], v[64:67], a[4:7]
    ds_read2_b32 v[112:113], v10 offset0:0 offset1:1
    v_mfma_f32_16x16x32_bf16 a[8:11], v[36:39], v[68:71], a[8:11]
    ds_read2_b32 v[114:115], v10 offset0:2 offset1:3
    v_mfma_f32_16x16x32_bf16 a[12:15], v[36:39], v[72:75], a[12:15]
    ds_read2_b32 v[116:117], v10 offset0:128 offset1:129
    v_mfma_f32_16x16x32_bf16 a[16:19], v[36:39], v[76:79], a[16:19]
    ds_read2_b32 v[118:119], v10 offset0:130 offset1:131
    v_mfma_f32_16x16x32_bf16 a[20:23], v[36:39], v[80:83], a[20:23]
    ds_read2_b32 v[120:121], v11 offset0:0 offset1:1
    v_mfma_f32_16x16x32_bf16 a[24:27], v[36:39], v[84:87], a[24:27]
    ds_read2_b32 v[122:123], v11 offset0:2 offset1:3
    v_mfma_f32_16x16x32_bf16 a[28:31], v[36:39], v[88:91], a[28:31]
    ds_read2_b32 v[124:125], v11 offset0:128 offset1:129
    v_mfma_f32_16x16x32_bf16 a[8:11], v[40:43], v[64:67], a[8:11]
    ds_read2_b32 v[126:127], v11 offset0:130 offset1:131
    v_mfma_f32_16x16x32_bf16 a[12:15], v[40:43], v[68:71], a[12:15]
    ds_read_b128 v[128:131], v12 offset:0
    v_mfma_f32_16x16x32_bf16 a[16:19], v[40:43], v[72:75], a[16:19]
    ds_read_b128 v[132:135], v12 offset:512
    v_mfma_f32_16x16x32_bf16 a[20:23], v[40:43], v[76:79], a[20:23]
    ds_read_b128 v[136:139], v12 offset:1024
    v_mfma_f32_16x16x32_bf16 a[24:27], v[40:43], v[80:83], a[24:27]
    ds_read_b128 v[140:143], v12 offset:1536
    v_mfma_f32_16x16x32_bf16 a[28:31], v[40:43], v[84:87], a[28:31]
    ds_read_b128 v[144:147], v12 offset:2048
    v_mfma_f32_16x16x32_bf16 a[12:15], v[44:47], v[64:67], a[12:15]
    ds_read_b128 v[148:151], v12 offset:2560
    v_mfma_f32_16x16x32_bf16 a[16:19], v[44:47], v[68:71], a[16:19]
    ds_read_b128 v[152:155], v12 offset:3072
    v_mfma_f32_16x16x32_bf16 a[20:23], v[44:47], v[72:75], a[20:23]
    ds_read_b128 v[156:159], v12 offset:3584
    v_mfma_f32_16x16x32_bf16 a[24:27], v[44:47], v[76:79], a[24:27]
    v_add_u32 v8, 64, v8
    v_mfma_f32_16x16x32_bf16 a[28:31], v[44:47], v[80:83], a[28:31]
    v_add_u32 v9, 64, v9
    v_mfma_f32_16x16x32_bf16 a[16:19], v[48:51], v[64:67], a[16:19]
    v_add_u32 v10, 64, v10
    v_mfma_f32_16x16x32_bf16 a[20:23], v[48:51], v[68:71], a[20:23]
    v_add_u32 v11, 64, v11
    v_mfma_f32_16x16x32_bf16 a[24:27], v[48:51], v[72:75], a[24:27]
    v_subrev_u32 v12, 64, v12
    v_mfma_f32_16x16x32_bf16 a[28:31], v[48:51], v[76:79], a[28:31]
    v_mfma_f32_16x16x32_bf16 a[20:23], v[52:55], v[64:67], a[20:23]
    v_mfma_f32_16x16x32_bf16 a[24:27], v[52:55], v[68:71], a[24:27]
    v_mfma_f32_16x16x32_bf16 a[28:31], v[52:55], v[72:75], a[28:31]
    v_mfma_f32_16x16x32_bf16 a[24:27], v[56:59], v[64:67], a[24:27]
    v_mfma_f32_16x16x32_bf16 a[28:31], v[56:59], v[68:71], a[28:31]
    v_mfma_f32_16x16x32_bf16 a[28:31], v[60:63], v[64:67], a[28:31]
    s_waitcnt lgkmcnt(0)
    v_mfma_f32_16x16x32_bf16 a[0:3], v[96:99], v[128:131], a[0:3]
    ds_read2_b32 v[32:33], v8 offset0:0 offset1:1
    v_mfma_f32_16x16x32_bf16 a[4:7], v[96:99], v[132:135], a[4:7]
    ds_read2_b32 v[34:35], v8 offset0:2 offset1:3
    v_mfma_f32_16x16x32_bf16 a[8:11], v[96:99], v[136:139], a[8:11]
    ds_read2_b32 v[36:37], v8 offset0:128 offset1:129
    v_mfma_f32_16x16x32_bf16 a[12:15], v[96:99], v[140:143], a[12:15]
    ds_read2_b32 v[38:39], v8 offset0:130 offset1:131
    v_mfma_f32_16x16x32_bf16 a[16:19], v[96:99], v[144:147], a[16:19]
    ds_read2_b32 v[40:41], v9 offset0:0 offset1:1
    v_mfma_f32_16x16x32_bf16 a[20:23], v[96:99], v[148:151], a[20:23]
    ds_read2_b32 v[42:43], v9 offset0:2 offset1:3
    v_mfma_f32_16x16x32_bf16 a[24:27], v[96:99], v[152:155], a[24:27]
    ds_read2_b32 v[44:45], v9 offset0:128 offset1:129
    v_mfma_f32_16x16x32_bf16 a[28:31], v[96:99], v[156:159], a[28:31]
    ds_read2_b32 v[46:47], v9 offset0:130 offset1:131
    v_mfma_f32_16x16x32_bf16 a[4:7], v[100:103], v[128:131], a[4:7]
    ds_read2_b32 v[48:49], v10 offset0:0 offset1:1
    v_mfma_f32_16x16x32_bf16 a[8:11], v[100:103], v[132:135], a[8:11]
    ds_read2_b32 v[50:51], v10 offset0:2 offset1:3
    v_mfma_f32_16x16x32_bf16 a[12:15], v[100:103], v[136:139], a[12:15]
    ds_read2_b32 v[52:53], v10 offset0:128 offset1:129
    v_mfma_f32_16x16x32_bf16 a[16:19], v[100:103], v[140:143], a[16:19]
    ds_read2_b32 v[54:55], v10 offset0:130 offset1:131
    v_mfma_f32_16x16x32_bf16 a[20:23], v[100:103], v[144:147], a[20:23]
    ds_read2_b32 v[56:57], v11 offset0:0 offset1:1
    v_mfma_f32_16x16x32_bf16 a[24:27], v[100:103], v[148:151], a[24:27]
    ds_read2_b32 v[58:59], v11 offset0:2 offset1:3
    v_mfma_f32_16x16x32_bf16 a[28:31], v[100:103], v[152:155], a[28:31]
    ds_read2_b32 v[60:61], v11 offset0:128 offset1:129
    v_mfma_f32_16x16x32_bf16 a[8:11], v[104:107], v[128:131], a[8:11]
    ds_read2_b32 v[62:63], v11 offset0:130 offset1:131
    v_mfma_f32_16x16x32_bf16 a[12:15], v[104:107], v[132:135], a[12:15]
    ds_read_b128 v[64:67], v12 offset:0
    v_mfma_f32_16x16x32_bf16 a[16:19], v[104:107], v[136:139], a[16:19]
    ds_read_b128 v[68:71], v12 offset:512
    v_mfma_f32_16x16x32_bf16 a[20:23], v[104:107], v[140:143], a[20:23]
    ds_read_b128 v[72:75], v12 offset:1024
    v_mfma_f32_16x16x32_bf16 a[24:27], v[104:107], v[144:147], a[24:27]
    ds_read_b128 v[76:79], v12 offset:1536
    v_mfma_f32_16x16x32_bf16 a[28:31], v[104:107], v[148:151], a[28:31]
    ds_read_b128 v[80:83], v12 offset:2048
    v_mfma_f32_16x16x32_bf16 a[12:15], v[108:111], v[128:131], a[12:15]
    ds_read_b128 v[84:87], v12 offset:2560
    v_mfma_f32_16x16x32_bf16 a[16:19], v[108:111], v[132:135], a[16:19]
    ds_read_b128 v[88:91], v12 offset:3072
    v_mfma_f32_16x16x32_bf16 a[20:23], v[108:111], v[136:139], a[20:23]
    ds_read_b128 v[92:95], v12 offset:3584
    v_mfma_f32_16x16x32_bf16 a[24:27], v[108:111], v[140:143], a[24:27]
    v_add_u32 v8, 64, v8
    v_mfma_f32_16x16x32_bf16 a[28:31], v[108:111], v[144:147], a[28:31]
    v_add_u32 v9, 64, v9
    v_mfma_f32_16x16x32_bf16 a[16:19], v[112:115], v[128:131], a[16:19]
    v_add_u32 v10, 64, v10
    v_mfma_f32_16x16x32_bf16 a[20:23], v[112:115], v[132:135], a[20:23]
    v_add_u32 v11, 64, v11
    v_mfma_f32_16x16x32_bf16 a[24:27], v[112:115], v[136:139], a[24:27]
    v_subrev_u32 v12, 64, v12
    v_mfma_f32_16x16x32_bf16 a[28:31], v[112:115], v[140:143], a[28:31]
    v_mfma_f32_16x16x32_bf16 a[20:23], v[116:119], v[128:131], a[20:23]
    v_mfma_f32_16x16x32_bf16 a[24:27], v[116:119], v[132:135], a[24:27]
    v_mfma_f32_16x16x32_bf16 a[28:31], v[116:119], v[136:139], a[28:31]
    v_mfma_f32_16x16x32_bf16 a[24:27], v[120:123], v[128:131], a[24:27]
    v_mfma_f32_16x16x32_bf16 a[28:31], v[120:123], v[132:135], a[28:31]
    v_mfma_f32_16x16x32_bf16 a[28:31], v[124:127], v[128:131], a[28:31]
    s_waitcnt lgkmcnt(0)
    s_sub_u32 s10, s10, 1
    s_cmp_lg_u32 s10, 0
    s_cbranch_scc1 L_s4_conv
    v_mov_b32 v32, 163072
    s_mov_b32 s14, 640000
L_wg_21:
    ds_read_b32 v33, v32
    s_waitcnt lgkmcnt(0)
    v_cmp_gt_u32 vcc, 1, v33
    s_cbranch_vccz L_wgd_22
    s_sleep 1
    s_sub_u32 s14, s14, 1
    s_cmp_lg_u32 s14, 0
    s_cbranch_scc1 L_wg_21
L_wgd_22:
    v_and_b32 v13, 15, v0
    v_lshlrev_b32 v13, 5, v13
    v_lshrrev_b32 v14, 4, v0
    v_lshlrev_b32 v15, 3, v14
    v_add_u32 v15, v13, v15
    v_add_u32 v16, 0, v15
    v_add_u32 v17, s69, v15
    v_lshrrev_b32 v18, 1, v14
    v_lshlrev_b32 v18, 4, v18
    v_and_b32 v19, 1, v14
    v_lshlrev_b32 v19, 3, v19
    v_sub_u32 v18, v18, v19
    v_add_u32 v18, v13, v18
    v_add_u32 v18, 10568, v18
    v_add_u32 v18, s69, v18
    ds_read_b64 v[32:33], v18 offset:0
    ds_read_b64 v[34:35], v16 offset:0
    ds_read_b64 v[36:37], v18 offset:512
    ds_read_b64 v[38:39], v16 offset:512
    ds_read_b64 v[40:41], v18 offset:1024
    ds_read_b64 v[42:43], v16 offset:1024
    ds_read_b64 v[44:45], v18 offset:1536
    ds_read_b64 v[46:47], v16 offset:1536
    ds_read_b64 v[48:49], v18 offset:2048
    ds_read_b64 v[50:51], v16 offset:2048
    ds_read_b64 v[52:53], v18 offset:2560
    ds_read_b64 v[54:55], v16 offset:2560
    ds_read_b64 v[56:57], v18 offset:3072
    ds_read_b64 v[58:59], v16 offset:3072
    ds_read_b64 v[60:61], v18 offset:3584
    ds_read_b64 v[62:63], v16 offset:3584
    v_accvgpr_read_b32 v64, a0
    v_accvgpr_read_b32 v65, a1
    v_accvgpr_read_b32 v66, a2
    v_accvgpr_read_b32 v67, a3
    v_accvgpr_read_b32 v68, a4
    v_accvgpr_read_b32 v69, a5
    v_accvgpr_read_b32 v70, a6
    v_accvgpr_read_b32 v71, a7
    v_accvgpr_read_b32 v72, a8
    v_accvgpr_read_b32 v73, a9
    v_accvgpr_read_b32 v74, a10
    v_accvgpr_read_b32 v75, a11
    v_accvgpr_read_b32 v76, a12
    v_accvgpr_read_b32 v77, a13
    v_accvgpr_read_b32 v78, a14
    v_accvgpr_read_b32 v79, a15
    v_accvgpr_read_b32 v80, a16
    v_accvgpr_read_b32 v81, a17
    v_accvgpr_read_b32 v82, a18
    v_accvgpr_read_b32 v83, a19
    v_accvgpr_read_b32 v84, a20
    v_accvgpr_read_b32 v85, a21
    v_accvgpr_read_b32 v86, a22
    v_accvgpr_read_b32 v87, a23
    v_accvgpr_read_b32 v88, a24
    v_accvgpr_read_b32 v89, a25
    v_accvgpr_read_b32 v90, a26
    v_accvgpr_read_b32 v91, a27
    v_accvgpr_read_b32 v92, a28
    v_accvgpr_read_b32 v93, a29
    v_accvgpr_read_b32 v94, a30
    v_accvgpr_read_b32 v95, a31
    s_waitcnt lgkmcnt(0)
    v_and_b32 v100, 0xffff0000, v33
    v_lshlrev_b32 v101, 16, v33
    v_and_b32 v102, 0xffff0000, v32
    v_lshlrev_b32 v103, 16, v32
    v_lshlrev_b32 v104, 16, v34
    v_and_b32 v105, 0xffff0000, v34
    v_lshlrev_b32 v106, 16, v35
    v_and_b32 v107, 0xffff0000, v35
    v_fma_f32 v64, s72, v100, v64
    v_fma_f32 v65, s72, v101, v65
    v_fma_f32 v66, s72, v102, v66
    v_fma_f32 v67, s72, v103, v67
    v_fma_f32 v100, s71, v100, -v64
    v_fma_f32 v101, s71, v101, -v65
    v_fma_f32 v102, s71, v102, -v66
    v_fma_f32 v103, s71, v103, -v67
    v_fma_f32 v64, v104, v100, v64
    v_fma_f32 v65, v105, v101, v65
    v_fma_f32 v66, v106, v102, v66
    v_fma_f32 v67, v107, v103, v67
    v_cvt_pk_bf16_f32 v64, v64, v65
    v_cvt_pk_bf16_f32 v65, v66, v67
    ds_write_b64 v17, v[64:65] offset:1536
    v_and_b32 v100, 0xffff0000, v37
    v_lshlrev_b32 v101, 16, v37
    v_and_b32 v102, 0xffff0000, v36
    v_lshlrev_b32 v103, 16, v36
    v_lshlrev_b32 v104, 16, v38
    v_and_b32 v105, 0xffff0000, v38
    v_lshlrev_b32 v106, 16, v39
    v_and_b32 v107, 0xffff0000, v39
    v_fma_f32 v68, s72, v100, v68
    v_fma_f32 v69, s72, v101, v69
    v_fma_f32 v70, s72, v102, v70
    v_fma_f32 v71, s72, v103, v71
    v_fma_f32 v100, s71, v100, -v68
    v_fma_f32 v101, s71, v101, -v69
    v_fma_f32 v102, s71, v102, -v70
    v_fma_f32 v103, s71, v103, -v71
    v_fma_f32 v68, v104, v100, v68
    v_fma_f32 v69, v105, v101, v69
    v_fma_f32 v70, v106, v102, v70
    v_fma_f32 v71, v107, v103, v71
    v_cvt_pk_bf16_f32 v68, v68, v69
    v_cvt_pk_bf16_f32 v69, v70, v71
    ds_write_b64 v17, v[68:69] offset:2048
    v_and_b32 v100, 0xffff0000, v41
    v_lshlrev_b32 v101, 16, v41
    v_and_b32 v102, 0xffff0000, v40
    v_lshlrev_b32 v103, 16, v40
    v_lshlrev_b32 v104, 16, v42
    v_and_b32 v105, 0xffff0000, v42
    v_lshlrev_b32 v106, 16, v43
    v_and_b32 v107, 0xffff0000, v43
    v_fma_f32 v72, s72, v100, v72
    v_fma_f32 v73, s72, v101, v73
    v_fma_f32 v74, s72, v102, v74
    v_fma_f32 v75, s72, v103, v75
    v_fma_f32 v100, s71, v100, -v72
    v_fma_f32 v101, s71, v101, -v73
    v_fma_f32 v102, s71, v102, -v74
    v_fma_f32 v103, s71, v103, -v75
    v_fma_f32 v72, v104, v100, v72
    v_fma_f32 v73, v105, v101, v73
    v_fma_f32 v74, v106, v102, v74
    v_fma_f32 v75, v107, v103, v75
    v_cvt_pk_bf16_f32 v72, v72, v73
    v_cvt_pk_bf16_f32 v73, v74, v75
    ds_write_b64 v17, v[72:73] offset:2560
    v_and_b32 v100, 0xffff0000, v45
    v_lshlrev_b32 v101, 16, v45
    v_and_b32 v102, 0xffff0000, v44
    v_lshlrev_b32 v103, 16, v44
    v_lshlrev_b32 v104, 16, v46
    v_and_b32 v105, 0xffff0000, v46
    v_lshlrev_b32 v106, 16, v47
    v_and_b32 v107, 0xffff0000, v47
    v_fma_f32 v76, s72, v100, v76
    v_fma_f32 v77, s72, v101, v77
    v_fma_f32 v78, s72, v102, v78
    v_fma_f32 v79, s72, v103, v79
    v_fma_f32 v100, s71, v100, -v76
    v_fma_f32 v101, s71, v101, -v77
    v_fma_f32 v102, s71, v102, -v78
    v_fma_f32 v103, s71, v103, -v79
    v_fma_f32 v76, v104, v100, v76
    v_fma_f32 v77, v105, v101, v77
    v_fma_f32 v78, v106, v102, v78
    v_fma_f32 v79, v107, v103, v79
    v_cvt_pk_bf16_f32 v76, v76, v77
    v_cvt_pk_bf16_f32 v77, v78, v79
    ds_write_b64 v17, v[76:77] offset:3072
    v_and_b32 v100, 0xffff0000, v49
    v_lshlrev_b32 v101, 16, v49
    v_and_b32 v102, 0xffff0000, v48
    v_lshlrev_b32 v103, 16, v48
    v_lshlrev_b32 v104, 16, v50
    v_and_b32 v105, 0xffff0000, v50
    v_lshlrev_b32 v106, 16, v51
    v_and_b32 v107, 0xffff0000, v51
    v_fma_f32 v80, s72, v100, v80
    v_fma_f32 v81, s72, v101, v81
    v_fma_f32 v82, s72, v102, v82
    v_fma_f32 v83, s72, v103, v83
    v_fma_f32 v100, s71, v100, -v80
    v_fma_f32 v101, s71, v101, -v81
    v_fma_f32 v102, s71, v102, -v82
    v_fma_f32 v103, s71, v103, -v83
    v_fma_f32 v80, v104, v100, v80
    v_fma_f32 v81, v105, v101, v81
    v_fma_f32 v82, v106, v102, v82
    v_fma_f32 v83, v107, v103, v83
    v_cvt_pk_bf16_f32 v80, v80, v81
    v_cvt_pk_bf16_f32 v81, v82, v83
    ds_write_b64 v17, v[80:81] offset:3584
    v_and_b32 v100, 0xffff0000, v53
    v_lshlrev_b32 v101, 16, v53
    v_and_b32 v102, 0xffff0000, v52
    v_lshlrev_b32 v103, 16, v52
    v_lshlrev_b32 v104, 16, v54
    v_and_b32 v105, 0xffff0000, v54
    v_lshlrev_b32 v106, 16, v55
    v_and_b32 v107, 0xffff0000, v55
    v_fma_f32 v84, s72, v100, v84
    v_fma_f32 v85, s72, v101, v85
    v_fma_f32 v86, s72, v102, v86
    v_fma_f32 v87, s72, v103, v87
    v_fma_f32 v100, s71, v100, -v84
    v_fma_f32 v101, s71, v101, -v85
    v_fma_f32 v102, s71, v102, -v86
    v_fma_f32 v103, s71, v103, -v87
    v_fma_f32 v84, v104, v100, v84
    v_fma_f32 v85, v105, v101, v85
    v_fma_f32 v86, v106, v102, v86
    v_fma_f32 v87, v107, v103, v87
    v_cvt_pk_bf16_f32 v84, v84, v85
    v_cvt_pk_bf16_f32 v85, v86, v87
    ds_write_b64 v17, v[84:85] offset:4096
    v_and_b32 v100, 0xffff0000, v57
    v_lshlrev_b32 v101, 16, v57
    v_and_b32 v102, 0xffff0000, v56
    v_lshlrev_b32 v103, 16, v56
    v_lshlrev_b32 v104, 16, v58
    v_and_b32 v105, 0xffff0000, v58
    v_lshlrev_b32 v106, 16, v59
    v_and_b32 v107, 0xffff0000, v59
    v_fma_f32 v88, s72, v100, v88
    v_fma_f32 v89, s72, v101, v89
    v_fma_f32 v90, s72, v102, v90
    v_fma_f32 v91, s72, v103, v91
    v_fma_f32 v100, s71, v100, -v88
    v_fma_f32 v101, s71, v101, -v89
    v_fma_f32 v102, s71, v102, -v90
    v_fma_f32 v103, s71, v103, -v91
    v_fma_f32 v88, v104, v100, v88
    v_fma_f32 v89, v105, v101, v89
    v_fma_f32 v90, v106, v102, v90
    v_fma_f32 v91, v107, v103, v91
    v_cvt_pk_bf16_f32 v88, v88, v89
    v_cvt_pk_bf16_f32 v89, v90, v91
    ds_write_b64 v17, v[88:89] offset:4608
    v_and_b32 v100, 0xffff0000, v61
    v_lshlrev_b32 v101, 16, v61
    v_and_b32 v102, 0xffff0000, v60
    v_lshlrev_b32 v103, 16, v60
    v_lshlrev_b32 v104, 16, v62
    v_and_b32 v105, 0xffff0000, v62
    v_lshlrev_b32 v106, 16, v63
    v_and_b32 v107, 0xffff0000, v63
    v_fma_f32 v92, s72, v100, v92
    v_fma_f32 v93, s72, v101, v93
    v_fma_f32 v94, s72, v102, v94
    v_fma_f32 v95, s72, v103, v95
    v_fma_f32 v100, s71, v100, -v92
    v_fma_f32 v101, s71, v101, -v93
    v_fma_f32 v102, s71, v102, -v94
    v_fma_f32 v103, s71, v103, -v95
    v_fma_f32 v92, v104, v100, v92
    v_fma_f32 v93, v105, v101, v93
    v_fma_f32 v94, v106, v102, v94
    v_fma_f32 v95, v107, v103, v95
    v_cvt_pk_bf16_f32 v92, v92, v93
    v_cvt_pk_bf16_f32 v93, v94, v95
    ds_write_b64 v17, v[92:93] offset:5120
    v_lshlrev_b32 v30, 4, v0
    v_add_u32 v31, s69, v30
    s_waitcnt lgkmcnt(0)
    ds_read_b128 v[32:35], v31 offset:1536
    ds_read_b128 v[36:39], v31 offset:2560
    ds_read_b128 v[40:43], v31 offset:3584
    ds_read_b128 v[44:47], v31 offset:4608
    s_lshl_b32 s10, s68, 12
    s_add_u32 s10, s10, 4194304
    s_waitcnt lgkmcnt(3)
    buffer_store_dwordx4 v[32:35], v30, s[60:63], s10 offen offset:0 sc1
    s_waitcnt lgkmcnt(2)
    buffer_store_dwordx4 v[36:39], v30, s[60:63], s10 offen offset:1024 sc1
    s_waitcnt lgkmcnt(1)
    buffer_store_dwordx4 v[40:43], v30, s[60:63], s10 offen offset:2048 sc1
    s_waitcnt lgkmcnt(0)
    buffer_store_dwordx4 v[44:47], v30, s[60:63], s10 offen offset:3072 sc1
    s_waitcnt vmcnt(0)
    s_lshl_b32 s10, s68, 2
    s_add_u32 s10, s10, 16384
    v_mov_b32 v32, s8
    v_mov_b32 v33, 0
    s_mov_b64 exec, 1
    buffer_store_dword v32, v33, s[60:63], s10 offen sc1
    s_branch L_exit
L_s5:
    s_setprio 2
    v_and_b32 v1, 7, v0
    v_lshlrev_b32 v1, 1, v1
    s_mul_i32 s68, s5, 80
    s_add_u32 s9, s3, 0
    s_mul_hi_u32 s10, s9, 0x33333334
    s_mul_i32 s11, s10, 5
    s_sub_u32 s11, s9, s11
    s_mov_b32 s70, s10
    s_mov_b32 s71, s11
    s_lshl_b32 s11, s11, 4
    s_add_u32 s11, s11, s68
    v_add_u32 v2, s11, v1
    global_load_ushort v56, v2, s[18:19]
    global_load_ushort v57, v2, s[20:21]
    global_load_ushort v58, v2, s[30:31]
    s_add_u32 s9, s3, 4
    s_mul_hi_u32 s10, s9, 0x33333334
    s_mul_i32 s11, s10, 5
    s_sub_u32 s11, s9, s11
    s_mov_b32 s72, s10
    s_mov_b32 s73, s11
    s_lshl_b32 s11, s11, 4
    s_add_u32 s11, s11, s68
    v_add_u32 v2, s11, v1
    global_load_ushort v59, v2, s[18:19]
    global_load_ushort v60, v2, s[20:21]
    global_load_ushort v61, v2, s[30:31]
    s_add_u32 s9, s3, 8
    s_mul_hi_u32 s10, s9, 0x33333334
    s_mul_i32 s11, s10, 5
    s_sub_u32 s11, s9, s11
    s_mov_b32 s74, s10
    s_mov_b32 s75, s11
    s_lshl_b32 s11, s11, 4
    s_add_u32 s11, s11, s68
    v_add_u32 v2, s11, v1
    global_load_ushort v62, v2, s[18:19]
    global_load_ushort v63, v2, s[20:21]
    global_load_ushort v64, v2, s[30:31]
    s_add_u32 s9, s3, 12
    s_mul_hi_u32 s10, s9, 0x33333334
    s_mul_i32 s11, s10, 5
    s_sub_u32 s11, s9, s11
    s_mov_b32 s76, s10
    s_mov_b32 s77, s11
    s_lshl_b32 s11, s11, 4
    s_add_u32 s11, s11, s68
    v_add_u32 v2, s11, v1
    v_min_u32 v2, 1278, v2
    global_load_ushort v65, v2, s[18:19]
    global_load_ushort v66, v2, s[20:21]
    global_load_ushort v67, v2, s[30:31]
    v_lshrrev_b32 v2, 3, v0
    v_and_b32 v3, 6, v2
    v_and_b32 v4, 7, v0
    v_xor_b32 v3, v3, v4
    v_lshlrev_b32 v3, 4, v3
    v_lshrrev_b32 v4, 2, v2
    v_lshlrev_b32 v4, 3, v4
    v_and_b32 v5, 3, v2
    v_add_u32 v4, v4, v5
    v_add_u32 v5, 0, v4
    v_mul_u32_u24 v5, 1280, v5
    v_add_u32 v6, v5, v3
    v_add_u32 v5, 16, v4
    v_mul_u32_u24 v5, 1280, v5
    v_add_u32 v7, v5, v3
    v_add_u32 v5, 4, v4
    v_mul_u32_u24 v5, 1280, v5
    v_add_u32 v8, v5, v3
    v_add_u32 v5, 20, v4
    v_mul_u32_u24 v5, 1280, v5
    v_add_u32 v9, v5, v3
    s_lshl_b32 s9, s4, 2
    s_add_u32 s9, s9, s3
    s_mul_i32 s9, s9, 40960
    s_add_u32 s78, s16, s9
    s_addc_u32 s79, s17, 0
    s_lshr_b32 s86, s2, 7
    s_mul_i32 s86, s86, 5
    s_add_u32 s86, s86, s5
    s_and_b32 s9, s2, 7
    s_add_u32 s86, s86, s9
    s_cmp_ge_u32 s86, 10
    s_cselect_b32 s9, 10, 0
    s_sub_u32 s86, s86, s9
    s_cmp_ge_u32 s86, 10
    s_cselect_b32 s9, 10, 0
    s_sub_u32 s86, s86, s9
    s_cmp_ge_u32 s86, 10
    s_cselect_b32 s9, 10, 0
    s_sub_u32 s86, s86, s9
    s_lshl_b32 s9, s86, 7
    s_add_u32 s78, s78, s9
    s_addc_u32 s79, s79, 0
    s_sub_u32 s80, s78, 1280
    s_subb_u32 s81, s79, 0
    v_mul_u32_u24 v10, 1280, v2
    v_add_u32 v10, v10, v3
    s_mul_i32 s93, s3, 12288
    s_add_u32 s93, s93, 4096
    s_lshl_b32 s9, s3, 2
    s_add_u32 s9, s9, 163088
    v_mov_b32 v14, s9
    v_and_b32 v15, 3, v0
    v_lshlrev_b32 v15, 2, v15
    v_add_u32 v15, 163088, v15
    s_barrier
    v_lshrrev_b32 v68, 3, v0
    v_subrev_u32 v69, 1, v68
    v_lshlrev_b32 v69, 3, v69
    v_subrev_u32 v70, 4, v68
    v_lshlrev_b32 v70, 5, v70
    v_cmp_lt_u32 vcc, 5, v68
    s_nop 1
    v_cndmask_b32 v69, v69, v70, vcc
    v_cmp_gt_u32 vcc, 2, v68
    s_nop 1
    v_cndmask_b32 v69, v69, v68, vcc
    s_waitcnt lgkmcnt(0)
    s_mul_i32 s8, s8, 0x9E3779B1
    s_add_u32 s8, s8, 0x7F4A7C15
    s_waitcnt vmcnt(0)
    v_lshlrev_b32 v56, 16, v56
    v_lshlrev_b32 v57, 16, v57
    v_lshlrev_b32 v58, 16, v58
    v_mul_f32 v58, 0x3FB8AA3B, v58
    v_exp_f32 v58, v58
    s_nop 0
    v_cvt_pk_bf16_f32 v58, v58, v58
    v_lshlrev_b32 v58, 16, v58
    s_lshl_b32 s9, s70, 3
    s_sub_u32 s9, s9, 7
    v_add_u32 v70, s9, v68
    v_lshlrev_b32 v70, 7, v70
    s_cmp_eq_u32 s70, 0
    s_cselect_b64 s[10:11], -1, 0
    s_nop 0
    v_cndmask_b32 v70, v70, v69, s[10:11]
    s_cmp_eq_u32 s70, 2
    s_cselect_b64 s[10:11], -1, 0
    v_cmp_eq_u32 vcc, 6, v68
    s_and_b64 s[10:11], s[10:11], vcc
    s_nop 1
    v_cndmask_b32 v70, v70, 1, s[10:11]
    v_cvt_f32_u32 v70, v70
    v_mul_f32 v71, v58, v56
    v_mul_f32 v71, 0x3FB8AA3B, v71
    v_mul_f32 v72, v58, v57
    v_mul_f32 v72, 0x3E22F983, v72
    v_mul_f32 v71, v70, v71
    v_mul_f32 v72, v70, v72
    v_exp_f32 v71, v71
    v_fract_f32 v72, v72
    v_cos_f32 v74, v72
    v_sin_f32 v75, v72
    s_nop 0
    v_mul_f32 v74, v71, v74
    v_mul_f32 v75, v71, v75
    v_add_f32 v76, -1.0, v74
    v_mul_f32 v77, v76, v56
    v_fmac_f32 v77, v75, v57
    v_mul_f32 v78, v75, v56
    v_fma_f32 v78, -v76, v57, v78
    v_mul_f32 v79, v56, v56
    v_fmac_f32 v79, v57, v57
    v_rcp_f32 v79, v79
    s_nop 0
    v_add_f32 v79, v79, v79
    v_mul_f32 v77, v77, v79
    v_mul_f32 v78, v78, v79
    v_cndmask_b32 v74, v74, v77, s[10:11]
    v_cndmask_b32 v75, v75, v78, s[10:11]
    s_lshl_b32 s9, s70, 3
    v_add_u32 v76, s9, v68
    v_mul_u32_u24 v76, 40, v76
    s_lshl_b32 s9, s71, 3
    v_add_u32 v76, s9, v76
    v_and_b32 v77, 7, v0
    v_add_u32 v76, v76, v77
    v_lshlrev_b32 v76, 3, v76
    v_add_u32 v76, 94208, v76
    ds_write_b64 v76, v[74:75]
L_ctskip_23:
    v_lshlrev_b32 v59, 16, v59
    v_lshlrev_b32 v60, 16, v60
    v_lshlrev_b32 v61, 16, v61
    v_mul_f32 v61, 0x3FB8AA3B, v61
    v_exp_f32 v61, v61
    s_nop 0
    v_cvt_pk_bf16_f32 v61, v61, v61
    v_lshlrev_b32 v61, 16, v61
    s_lshl_b32 s9, s72, 3
    s_sub_u32 s9, s9, 7
    v_add_u32 v70, s9, v68
    v_lshlrev_b32 v70, 7, v70
    s_cmp_eq_u32 s72, 0
    s_cselect_b64 s[10:11], -1, 0
    s_nop 0
    v_cndmask_b32 v70, v70, v69, s[10:11]
    s_cmp_eq_u32 s72, 2
    s_cselect_b64 s[10:11], -1, 0
    v_cmp_eq_u32 vcc, 6, v68
    s_and_b64 s[10:11], s[10:11], vcc
    s_nop 1
    v_cndmask_b32 v70, v70, 1, s[10:11]
    v_cvt_f32_u32 v70, v70
    v_mul_f32 v71, v61, v59
    v_mul_f32 v71, 0x3FB8AA3B, v71
    v_mul_f32 v72, v61, v60
    v_mul_f32 v72, 0x3E22F983, v72
    v_mul_f32 v71, v70, v71
    v_mul_f32 v72, v70, v72
    v_exp_f32 v71, v71
    v_fract_f32 v72, v72
    v_cos_f32 v74, v72
    v_sin_f32 v75, v72
    s_nop 0
    v_mul_f32 v74, v71, v74
    v_mul_f32 v75, v71, v75
    v_add_f32 v76, -1.0, v74
    v_mul_f32 v77, v76, v59
    v_fmac_f32 v77, v75, v60
    v_mul_f32 v78, v75, v59
    v_fma_f32 v78, -v76, v60, v78
    v_mul_f32 v79, v59, v59
    v_fmac_f32 v79, v60, v60
    v_rcp_f32 v79, v79
    s_nop 0
    v_add_f32 v79, v79, v79
    v_mul_f32 v77, v77, v79
    v_mul_f32 v78, v78, v79
    v_cndmask_b32 v74, v74, v77, s[10:11]
    v_cndmask_b32 v75, v75, v78, s[10:11]
    s_lshl_b32 s9, s72, 3
    v_add_u32 v76, s9, v68
    v_mul_u32_u24 v76, 40, v76
    s_lshl_b32 s9, s73, 3
    v_add_u32 v76, s9, v76
    v_and_b32 v77, 7, v0
    v_add_u32 v76, v76, v77
    v_lshlrev_b32 v76, 3, v76
    v_add_u32 v76, 94208, v76
    ds_write_b64 v76, v[74:75]
L_ctskip_24:
    v_lshlrev_b32 v62, 16, v62
    v_lshlrev_b32 v63, 16, v63
    v_lshlrev_b32 v64, 16, v64
    v_mul_f32 v64, 0x3FB8AA3B, v64
    v_exp_f32 v64, v64
    s_nop 0
    v_cvt_pk_bf16_f32 v64, v64, v64
    v_lshlrev_b32 v64, 16, v64
    s_lshl_b32 s9, s74, 3
    s_sub_u32 s9, s9, 7
    v_add_u32 v70, s9, v68
    v_lshlrev_b32 v70, 7, v70
    s_cmp_eq_u32 s74, 0
    s_cselect_b64 s[10:11], -1, 0
    s_nop 0
    v_cndmask_b32 v70, v70, v69, s[10:11]
    s_cmp_eq_u32 s74, 2
    s_cselect_b64 s[10:11], -1, 0
    v_cmp_eq_u32 vcc, 6, v68
    s_and_b64 s[10:11], s[10:11], vcc
    s_nop 1
    v_cndmask_b32 v70, v70, 1, s[10:11]
    v_cvt_f32_u32 v70, v70
    v_mul_f32 v71, v64, v62
    v_mul_f32 v71, 0x3FB8AA3B, v71
    v_mul_f32 v72, v64, v63
    v_mul_f32 v72, 0x3E22F983, v72
    v_mul_f32 v71, v70, v71
    v_mul_f32 v72, v70, v72
    v_exp_f32 v71, v71
    v_fract_f32 v72, v72
    v_cos_f32 v74, v72
    v_sin_f32 v75, v72
    s_nop 0
    v_mul_f32 v74, v71, v74
    v_mul_f32 v75, v71, v75
    v_add_f32 v76, -1.0, v74
    v_mul_f32 v77, v76, v62
    v_fmac_f32 v77, v75, v63
    v_mul_f32 v78, v75, v62
    v_fma_f32 v78, -v76, v63, v78
    v_mul_f32 v79, v62, v62
    v_fmac_f32 v79, v63, v63
    v_rcp_f32 v79, v79
    s_nop 0
    v_add_f32 v79, v79, v79
    v_mul_f32 v77, v77, v79
    v_mul_f32 v78, v78, v79
    v_cndmask_b32 v74, v74, v77, s[10:11]
    v_cndmask_b32 v75, v75, v78, s[10:11]
    s_lshl_b32 s9, s74, 3
    v_add_u32 v76, s9, v68
    v_mul_u32_u24 v76, 40, v76
    s_lshl_b32 s9, s75, 3
    v_add_u32 v76, s9, v76
    v_and_b32 v77, 7, v0
    v_add_u32 v76, v76, v77
    v_lshlrev_b32 v76, 3, v76
    v_add_u32 v76, 94208, v76
    ds_write_b64 v76, v[74:75]
L_ctskip_25:
    s_cmp_eq_u32 s3, 3
    s_cbranch_scc1 L_ctskip_26
    v_lshlrev_b32 v65, 16, v65
    v_lshlrev_b32 v66, 16, v66
    v_lshlrev_b32 v67, 16, v67
    v_mul_f32 v67, 0x3FB8AA3B, v67
    v_exp_f32 v67, v67
    s_nop 0
    v_cvt_pk_bf16_f32 v67, v67, v67
    v_lshlrev_b32 v67, 16, v67
    s_lshl_b32 s9, s76, 3
    s_sub_u32 s9, s9, 7
    v_add_u32 v70, s9, v68
    v_lshlrev_b32 v70, 7, v70
    s_cmp_eq_u32 s76, 0
    s_cselect_b64 s[10:11], -1, 0
    s_nop 0
    v_cndmask_b32 v70, v70, v69, s[10:11]
    s_cmp_eq_u32 s76, 2
    s_cselect_b64 s[10:11], -1, 0
    v_cmp_eq_u32 vcc, 6, v68
    s_and_b64 s[10:11], s[10:11], vcc
    s_nop 1
    v_cndmask_b32 v70, v70, 1, s[10:11]
    v_cvt_f32_u32 v70, v70
    v_mul_f32 v71, v67, v65
    v_mul_f32 v71, 0x3FB8AA3B, v71
    v_mul_f32 v72, v67, v66
    v_mul_f32 v72, 0x3E22F983, v72
    v_mul_f32 v71, v70, v71
    v_mul_f32 v72, v70, v72
    v_exp_f32 v71, v71
    v_fract_f32 v72, v72
    v_cos_f32 v74, v72
    v_sin_f32 v75, v72
    s_nop 0
    v_mul_f32 v74, v71, v74
    v_mul_f32 v75, v71, v75
    v_add_f32 v76, -1.0, v74
    v_mul_f32 v77, v76, v65
    v_fmac_f32 v77, v75, v66
    v_mul_f32 v78, v75, v65
    v_fma_f32 v78, -v76, v66, v78
    v_mul_f32 v79, v65, v65
    v_fmac_f32 v79, v66, v66
    v_rcp_f32 v79, v79
    s_nop 0
    v_add_f32 v79, v79, v79
    v_mul_f32 v77, v77, v79
    v_mul_f32 v78, v78, v79
    v_cndmask_b32 v74, v74, v77, s[10:11]
    v_cndmask_b32 v75, v75, v78, s[10:11]
    s_lshl_b32 s9, s76, 3
    v_add_u32 v76, s9, v68
    v_mul_u32_u24 v76, 40, v76
    s_lshl_b32 s9, s77, 3
    v_add_u32 v76, s9, v76
    v_and_b32 v77, 7, v0
    v_add_u32 v76, v76, v77
    v_lshlrev_b32 v76, 3, v76
    v_add_u32 v76, 94208, v76
    ds_write_b64 v76, v[74:75]
L_ctskip_26:
    s_waitcnt lgkmcnt(0)
    v_mov_b32 v13, 1
    s_mov_b64 exec, 1
    ds_write_b32 v14, v13
    s_mov_b64 exec, -1
    s_mov_b32 s14, 640000
L_s5w_27:
    ds_read_b32 v13, v15
    s_waitcnt lgkmcnt(0)
    v_cmp_gt_u32 vcc, 1, v13
    s_cbranch_vccz L_s5wd_28
    s_sub_u32 s14, s14, 1
    s_cmp_lg_u32 s14, 0
    s_cbranch_scc1 L_s5w_27
L_s5wd_28:
    v_lshrrev_b32 v56, 4, v0
    v_and_b32 v57, 7, v0
    v_lshlrev_b32 v57, 3, v57
    v_add_u32 v57, 94208, v57
    v_add_u32 v58, 320, v57
    ds_read_b64 v[90:91], v58 offset:0
    ds_read_b64 v[92:93], v58 offset:64
    ds_read_b64 v[94:95], v58 offset:128
    ds_read_b64 v[96:97], v58 offset:192
    ds_read_b64 v[98:99], v58 offset:256
    v_add_u32 v59, 640, v57
    ds_read_b64 v[100:101], v59 offset:0
    ds_read_b64 v[102:103], v59 offset:64
    ds_read_b64 v[104:105], v59 offset:128
    ds_read_b64 v[106:107], v59 offset:192
    ds_read_b64 v[108:109], v59 offset:256
    v_add_u32 v60, 1, v56
    v_cmp_eq_u32 vcc, 0, v56
    s_nop 1
    v_cndmask_b32 v60, v60, 0, vcc
    v_mul_u32_u24 v60, 320, v60
    v_add_u32 v60, v60, v57
    ds_read_b64 v[110:111], v60 offset:0
    ds_read_b64 v[112:113], v60 offset:64
    ds_read_b64 v[114:115], v60 offset:128
    ds_read_b64 v[116:117], v60 offset:192
    ds_read_b64 v[118:119], v60 offset:256
    v_add_u32 v61, 1600, v57
    ds_read_b64 v[120:121], v61 offset:0
    ds_read_b64 v[122:123], v61 offset:64
    ds_read_b64 v[124:125], v61 offset:128
    ds_read_b64 v[126:127], v61 offset:192
    ds_read_b64 v[128:129], v61 offset:256
    s_waitcnt lgkmcnt(0)
    s_add_u32 s9, s3, 4
    s_cmp_eq_u32 s3, 0
    s_cselect_b32 s9, 0, s9
    s_mul_i32 s9, s9, 320
    v_add_u32 v62, s9, v57
    ds_read_b64 v[130:131], v62 offset:0
    ds_read_b64 v[132:133], v62 offset:64
    ds_read_b64 v[134:135], v62 offset:128
    ds_read_b64 v[136:137], v62 offset:192
    ds_read_b64 v[138:139], v62 offset:256
    s_lshl_b32 s9, s3, 2
    s_sub_u32 s9, s4, s9
    s_sub_u32 s9, s9, 1
    v_sub_u32 v63, s9, v56
    v_add_u32 v64, 7, v63
    v_cmp_gt_i32 vcc, 1, v63
    s_nop 1
    v_cndmask_b32 v64, v64, 0, vcc
    v_mul_u32_u24 v64, 320, v64
    v_add_u32 v64, v64, v57
    ds_read_b64 v[140:141], v64 offset:0
    ds_read_b64 v[142:143], v64 offset:64
    ds_read_b64 v[144:145], v64 offset:128
    ds_read_b64 v[146:147], v64 offset:192
    ds_read_b64 v[148:149], v64 offset:256
    v_add_u32 v65, 7040, v57
    ds_read_b64 v[150:151], v65 offset:0
    ds_read_b64 v[152:153], v65 offset:64
    ds_read_b64 v[154:155], v65 offset:128
    ds_read_b64 v[156:157], v65 offset:192
    ds_read_b64 v[158:159], v65 offset:256
    v_cmp_le_i32 s[94:95], 0, v63
    v_and_b32 v66, 8, v0
    v_lshlrev_b32 v67, 28, v66
    v_xor_b32 v66, 0x80000000, v67
    s_waitcnt lgkmcnt(0)
    v_xor_b32 v91, v66, v91
    v_xor_b32 v93, v66, v93
    v_xor_b32 v95, v66, v95
    v_xor_b32 v97, v66, v97
    v_xor_b32 v99, v66, v99
    v_xor_b32 v101, v66, v101
    v_xor_b32 v103, v66, v103
    v_xor_b32 v105, v66, v105
    v_xor_b32 v107, v66, v107
    v_xor_b32 v109, v66, v109
    v_xor_b32 v111, v66, v111
    v_xor_b32 v113, v66, v113
    v_xor_b32 v115, v66, v115
    v_xor_b32 v117, v66, v117
    v_xor_b32 v119, v66, v119
    v_xor_b32 v121, v66, v121
    v_xor_b32 v123, v66, v123
    v_xor_b32 v125, v66, v125
    v_xor_b32 v127, v66, v127
    v_xor_b32 v129, v66, v129
    v_xor_b32 v131, v66, v131
    v_xor_b32 v133, v66, v133
    v_xor_b32 v135, v66, v135
    v_xor_b32 v137, v66, v137
    v_xor_b32 v139, v66, v139
    v_xor_b32 v141, v66, v141
    v_xor_b32 v143, v66, v143
    v_xor_b32 v145, v66, v145
    v_xor_b32 v147, v66, v147
    v_xor_b32 v149, v66, v149
    v_xor_b32 v150, v67, v150
    v_xor_b32 v151, 0x80000000, v151
    v_xor_b32 v152, v67, v152
    v_xor_b32 v153, 0x80000000, v153
    v_xor_b32 v154, v67, v154
    v_xor_b32 v155, 0x80000000, v155
    v_xor_b32 v156, v67, v156
    v_xor_b32 v157, 0x80000000, v157
    v_xor_b32 v158, v67, v158
    v_xor_b32 v159, 0x80000000, v159
    s_cmp_ge_u32 s86, 10
    s_cselect_b32 s82, s80, s78
    s_cselect_b32 s83, s81, s79
    s_add_u32 m0, s93, 0
    s_nop 0
    global_load_lds_dwordx4 v6, s[82:83] offset:0
    s_add_u32 m0, s93, 1024
    s_nop 0
    global_load_lds_dwordx4 v7, s[82:83] offset:0
    s_add_u32 m0, s93, 2048
    s_nop 0
    global_load_lds_dwordx4 v8, s[82:83] offset:0
    s_add_u32 m0, s93, 3072
    s_nop 0
    global_load_lds_dwordx4 v9, s[82:83] offset:0
    s_cmp_ge_u32 s86, 9
    s_cselect_b32 s82, s80, s78
    s_cselect_b32 s83, s81, s79
    s_add_u32 m0, s93, 3968
    s_nop 0
    global_load_lds_dwordx4 v6, s[82:83] offset:128
    s_add_u32 m0, s93, 4992
    s_nop 0
    global_load_lds_dwordx4 v7, s[82:83] offset:128
    s_add_u32 m0, s93, 6016
    s_nop 0
    global_load_lds_dwordx4 v8, s[82:83] offset:128
    s_add_u32 m0, s93, 7040
    s_nop 0
    global_load_lds_dwordx4 v9, s[82:83] offset:128
    s_cmp_ge_u32 s86, 8
    s_cselect_b32 s82, s80, s78
    s_cselect_b32 s83, s81, s79
    s_add_u32 m0, s93, 7936
    s_nop 0
    global_load_lds_dwordx4 v6, s[82:83] offset:256
    s_add_u32 m0, s93, 8960
    s_nop 0
    global_load_lds_dwordx4 v7, s[82:83] offset:256
    s_add_u32 m0, s93, 9984
    s_nop 0
    global_load_lds_dwordx4 v8, s[82:83] offset:256
    s_add_u32 m0, s93, 11008
    s_nop 0
    global_load_lds_dwordx4 v9, s[82:83] offset:256
    v_and_b32 v60, 15, v0
    v_lshrrev_b32 v61, 4, v0
    v_and_b32 v62, 6, v60
    v_xor_b32 v61, v61, v62
    v_lshlrev_b32 v61, 4, v61
    v_lshlrev_b32 v60, 7, v60
    v_add_u32 v60, v60, v61
    v_add_u32 v56, s93, v60
    v_xor_b32 v57, 64, v56
    v_add_u32 v58, 53248, v60
    v_xor_b32 v59, 64, v58
    s_lshl_b32 s9, s3, 2
    s_add_u32 s9, s9, 163104
    v_mov_b32 v60, s9
    v_mov_b32 v61, 163080
    s_waitcnt vmcnt(8)
    s_mov_b32 s14, 640000
L_ldw_29:
    ds_read_b32 v13, v61
    s_waitcnt lgkmcnt(0)
    v_cmp_gt_u32 vcc, 1, v13
    s_cbranch_vccz L_ldwd_30
    s_sub_u32 s14, s14, 1
    s_cmp_lg_u32 s14, 0
    s_cbranch_scc1 L_ldw_29
L_ldwd_30:
    ds_read_b128 a[0:3], v56 offset:0
    ds_read_b128 a[4:7], v56 offset:2048
    ds_read_b128 a[8:11], v58 offset:0
    ds_read_b128 a[12:15], v58 offset:2048
    ds_read_b128 a[16:19], v58 offset:4096
    ds_read_b128 a[20:23], v58 offset:6144
    ds_read_b128 a[24:27], v58 offset:8192
    ds_read_b128 a[28:31], v57 offset:0
    ds_read_b128 a[32:35], v57 offset:2048
    ds_read_b128 a[36:39], v59 offset:0
    ds_read_b128 a[40:43], v59 offset:2048
    ds_read_b128 a[44:47], v59 offset:4096
    ds_read_b128 a[48:51], v59 offset:6144
    ds_read_b128 a[52:55], v59 offset:8192
    s_waitcnt lgkmcnt(7)
    s_waitcnt vmcnt(4)
    s_mov_b32 s14, 640000
L_ldw_31:
    ds_read_b32 v13, v61
    s_waitcnt lgkmcnt(0)
    v_cmp_gt_u32 vcc, 2, v13
    s_cbranch_vccz L_ldwd_32
    s_sub_u32 s14, s14, 1
    s_cmp_lg_u32 s14, 0
    s_cbranch_scc1 L_ldw_31
L_ldwd_32:
    v_mfma_f32_16x16x32_bf16 v[16:19], a[0:3], a[8:11], 0
    ds_read_b128 a[56:59], v56 offset:4096
    v_mfma_f32_16x16x32_bf16 v[36:39], a[4:7], a[8:11], 0
    ds_read_b128 a[60:63], v56 offset:6144
    v_mfma_f32_16x16x32_bf16 v[20:23], a[0:3], a[12:15], 0
    ds_read_b128 a[64:67], v58 offset:10240
    v_mfma_f32_16x16x32_bf16 v[40:43], a[4:7], a[12:15], 0
    ds_read_b128 a[68:71], v58 offset:12288
    v_mfma_f32_16x16x32_bf16 v[24:27], a[0:3], a[16:19], 0
    ds_read_b128 a[72:75], v58 offset:14336
    v_mfma_f32_16x16x32_bf16 v[44:47], a[4:7], a[16:19], 0
    ds_read_b128 a[76:79], v58 offset:16384
    v_mfma_f32_16x16x32_bf16 v[28:31], a[0:3], a[20:23], 0
    ds_read_b128 a[80:83], v58 offset:18432
    v_mfma_f32_16x16x32_bf16 v[48:51], a[4:7], a[20:23], 0
    v_mfma_f32_16x16x32_bf16 v[32:35], a[0:3], a[24:27], 0
    v_mfma_f32_16x16x32_bf16 v[52:55], a[4:7], a[24:27], 0
    s_waitcnt lgkmcnt(7)
    s_cmp_ge_u32 s86, 7
    s_cselect_b32 s82, s80, s78
    s_cselect_b32 s83, s81, s79
    v_mfma_f32_16x16x32_bf16 v[16:19], a[28:31], a[36:39], v[16:19]
    v_mov_b32 v62, 1
    s_mov_b64 exec, 1
    ds_write_b32 v60, v62
    s_mov_b64 exec, -1
    s_add_u32 m0, s93, 4294966912
    v_mfma_f32_16x16x32_bf16 v[36:39], a[32:35], a[36:39], v[36:39]
    global_load_lds_dwordx4 v6, s[82:83] offset:384
    ds_read_b128 a[0:3], v57 offset:4096
    v_mfma_f32_16x16x32_bf16 v[20:23], a[28:31], a[40:43], v[20:23]
    ds_read_b128 a[4:7], v57 offset:6144
    v_mfma_f32_16x16x32_bf16 v[40:43], a[32:35], a[40:43], v[40:43]
    ds_read_b128 a[8:11], v59 offset:10240
    s_add_u32 m0, s93, 640
    v_mfma_f32_16x16x32_bf16 v[24:27], a[28:31], a[44:47], v[24:27]
    global_load_lds_dwordx4 v7, s[82:83] offset:384
    ds_read_b128 a[12:15], v59 offset:12288
    v_mfma_f32_16x16x32_bf16 v[44:47], a[32:35], a[44:47], v[44:47]
    ds_read_b128 a[16:19], v59 offset:14336
    v_mfma_f32_16x16x32_bf16 v[28:31], a[28:31], a[48:51], v[28:31]
    ds_read_b128 a[20:23], v59 offset:16384
    s_add_u32 m0, s93, 1664
    v_mfma_f32_16x16x32_bf16 v[48:51], a[32:35], a[48:51], v[48:51]
    global_load_lds_dwordx4 v8, s[82:83] offset:384
    ds_read_b128 a[24:27], v59 offset:18432
    v_mfma_f32_16x16x32_bf16 v[32:35], a[28:31], a[52:55], v[32:35]
    ds_read_b32 v13, v61
    s_add_u32 m0, s93, 2688
    v_mfma_f32_16x16x32_bf16 v[52:55], a[32:35], a[52:55], v[52:55]
    global_load_lds_dwordx4 v9, s[82:83] offset:384
    s_waitcnt lgkmcnt(9)
    s_waitcnt lgkmcnt(0)
    s_waitcnt vmcnt(4)
    v_cmp_gt_u32 vcc, 3, v13
    s_cbranch_vccz L_ldok_33
    s_mov_b32 s14, 640000
L_ldw_34:
    ds_read_b32 v13, v61
    s_waitcnt lgkmcnt(0)
    v_cmp_gt_u32 vcc, 3, v13
    s_cbranch_vccz L_ldwd_35
    s_sub_u32 s14, s14, 1
    s_cmp_lg_u32 s14, 0
    s_cbranch_scc1 L_ldw_34
L_ldwd_35:
L_ldok_33:
    v_mfma_f32_16x16x32_bf16 v[16:19], a[56:59], a[64:67], v[16:19]
    ds_read_b128 a[28:31], v56 offset:8192
    v_mfma_f32_16x16x32_bf16 v[36:39], a[60:63], a[64:67], v[36:39]
    ds_read_b128 a[32:35], v56 offset:10240
    v_mfma_f32_16x16x32_bf16 v[20:23], a[56:59], a[68:71], v[20:23]
    ds_read_b128 a[36:39], v58 offset:20480
    v_mfma_f32_16x16x32_bf16 v[40:43], a[60:63], a[68:71], v[40:43]
    ds_read_b128 a[40:43], v58 offset:22528
    v_mfma_f32_16x16x32_bf16 v[24:27], a[56:59], a[72:75], v[24:27]
    ds_read_b128 a[44:47], v58 offset:24576
    v_mfma_f32_16x16x32_bf16 v[44:47], a[60:63], a[72:75], v[44:47]
    ds_read_b128 a[48:51], v58 offset:26624
    v_mfma_f32_16x16x32_bf16 v[28:31], a[56:59], a[76:79], v[28:31]
    ds_read_b128 a[52:55], v58 offset:28672
    v_mfma_f32_16x16x32_bf16 v[48:51], a[60:63], a[76:79], v[48:51]
    v_mfma_f32_16x16x32_bf16 v[32:35], a[56:59], a[80:83], v[32:35]
    v_mfma_f32_16x16x32_bf16 v[52:55], a[60:63], a[80:83], v[52:55]
    s_waitcnt lgkmcnt(8)
    s_cmp_ge_u32 s86, 6
    s_cselect_b32 s82, s80, s78
    s_cselect_b32 s83, s81, s79
    v_mfma_f32_16x16x32_bf16 v[16:19], a[0:3], a[8:11], v[16:19]
    v_mov_b32 v62, 2
    s_mov_b64 exec, 1
    ds_write_b32 v60, v62
    s_mov_b64 exec, -1
    s_add_u32 m0, s93, 3584
    v_mfma_f32_16x16x32_bf16 v[36:39], a[4:7], a[8:11], v[36:39]
    global_load_lds_dwordx4 v6, s[82:83] offset:512
    ds_read_b128 a[56:59], v57 offset:8192
    v_mfma_f32_16x16x32_bf16 v[20:23], a[0:3], a[12:15], v[20:23]
    ds_read_b128 a[60:63], v57 offset:10240
    v_mfma_f32_16x16x32_bf16 v[40:43], a[4:7], a[12:15], v[40:43]
    ds_read_b128 a[64:67], v59 offset:20480
    s_add_u32 m0, s93, 4608
    v_mfma_f32_16x16x32_bf16 v[24:27], a[0:3], a[16:19], v[24:27]
    global_load_lds_dwordx4 v7, s[82:83] offset:512
    ds_read_b128 a[68:71], v59 offset:22528
    v_mfma_f32_16x16x32_bf16 v[44:47], a[4:7], a[16:19], v[44:47]
    ds_read_b128 a[72:75], v59 offset:24576
    v_mfma_f32_16x16x32_bf16 v[28:31], a[0:3], a[20:23], v[28:31]
    ds_read_b128 a[76:79], v59 offset:26624
    s_add_u32 m0, s93, 5632
    v_mfma_f32_16x16x32_bf16 v[48:51], a[4:7], a[20:23], v[48:51]
    global_load_lds_dwordx4 v8, s[82:83] offset:512
    ds_read_b128 a[80:83], v59 offset:28672
    v_mfma_f32_16x16x32_bf16 v[32:35], a[0:3], a[24:27], v[32:35]
    ds_read_b32 v13, v61
    s_add_u32 m0, s93, 6656
    v_mfma_f32_16x16x32_bf16 v[52:55], a[4:7], a[24:27], v[52:55]
    global_load_lds_dwordx4 v9, s[82:83] offset:512
    s_waitcnt lgkmcnt(9)
    s_waitcnt lgkmcnt(0)
    s_waitcnt vmcnt(4)
    v_cmp_gt_u32 vcc, 4, v13
    s_cbranch_vccz L_ldok_36
    s_mov_b32 s14, 640000
L_ldw_37:
    ds_read_b32 v13, v61
    s_waitcnt lgkmcnt(0)
    v_cmp_gt_u32 vcc, 4, v13
    s_cbranch_vccz L_ldwd_38
    s_sub_u32 s14, s14, 1
    s_cmp_lg_u32 s14, 0
    s_cbranch_scc1 L_ldw_37
L_ldwd_38:
L_ldok_36:
    v_mfma_f32_16x16x32_bf16 v[16:19], a[28:31], a[36:39], v[16:19]
    ds_read_b128 a[0:3], v56 offset:0
    v_mfma_f32_16x16x32_bf16 v[36:39], a[32:35], a[36:39], v[36:39]
    ds_read_b128 a[4:7], v56 offset:2048
    v_mfma_f32_16x16x32_bf16 v[20:23], a[28:31], a[40:43], v[20:23]
    ds_read_b128 a[8:11], v58 offset:30720
    v_mfma_f32_16x16x32_bf16 v[40:43], a[32:35], a[40:43], v[40:43]
    ds_read_b128 a[12:15], v58 offset:32768
    v_mfma_f32_16x16x32_bf16 v[24:27], a[28:31], a[44:47], v[24:27]
    ds_read_b128 a[16:19], v58 offset:34816
    v_mfma_f32_16x16x32_bf16 v[44:47], a[32:35], a[44:47], v[44:47]
    ds_read_b128 a[20:23], v58 offset:36864
    v_mfma_f32_16x16x32_bf16 v[28:31], a[28:31], a[48:51], v[28:31]
    ds_read_b128 a[24:27], v58 offset:38912
    v_mfma_f32_16x16x32_bf16 v[48:51], a[32:35], a[48:51], v[48:51]
    v_mfma_f32_16x16x32_bf16 v[32:35], a[28:31], a[52:55], v[32:35]
    v_mfma_f32_16x16x32_bf16 v[52:55], a[32:35], a[52:55], v[52:55]
    s_waitcnt lgkmcnt(8)
    s_cmp_ge_u32 s86, 5
    s_cselect_b32 s82, s80, s78
    s_cselect_b32 s83, s81, s79
    v_mfma_f32_16x16x32_bf16 v[16:19], a[56:59], a[64:67], v[16:19]
    v_mov_b32 v62, 3
    s_mov_b64 exec, 1
    ds_write_b32 v60, v62
    s_mov_b64 exec, -1
    s_add_u32 m0, s93, 7552
    v_mfma_f32_16x16x32_bf16 v[36:39], a[60:63], a[64:67], v[36:39]
    global_load_lds_dwordx4 v6, s[82:83] offset:640
    ds_read_b128 a[28:31], v57 offset:0
    v_mfma_f32_16x16x32_bf16 v[20:23], a[56:59], a[68:71], v[20:23]
    ds_read_b128 a[32:35], v57 offset:2048
    v_mfma_f32_16x16x32_bf16 v[40:43], a[60:63], a[68:71], v[40:43]
    ds_read_b128 a[36:39], v59 offset:30720
    s_add_u32 m0, s93, 8576
    v_mfma_f32_16x16x32_bf16 v[24:27], a[56:59], a[72:75], v[24:27]
    global_load_lds_dwordx4 v7, s[82:83] offset:640
    ds_read_b128 a[40:43], v59 offset:32768
    v_mfma_f32_16x16x32_bf16 v[44:47], a[60:63], a[72:75], v[44:47]
    ds_read_b128 a[44:47], v59 offset:34816
    v_mfma_f32_16x16x32_bf16 v[28:31], a[56:59], a[76:79], v[28:31]
    ds_read_b128 a[48:51], v59 offset:36864
    s_add_u32 m0, s93, 9600
    v_mfma_f32_16x16x32_bf16 v[48:51], a[60:63], a[76:79], v[48:51]
    global_load_lds_dwordx4 v8, s[82:83] offset:640
    ds_read_b128 a[52:55], v59 offset:38912
    v_mfma_f32_16x16x32_bf16 v[32:35], a[56:59], a[80:83], v[32:35]
    ds_read_b32 v13, v61
    s_add_u32 m0, s93, 10624
    v_mfma_f32_16x16x32_bf16 v[52:55], a[60:63], a[80:83], v[52:55]
    global_load_lds_dwordx4 v9, s[82:83] offset:640
    s_waitcnt lgkmcnt(9)
    s_waitcnt lgkmcnt(0)
    s_waitcnt vmcnt(4)
    v_cmp_gt_u32 vcc, 5, v13
    s_cbranch_vccz L_ldok_39
    s_mov_b32 s14, 640000
L_ldw_40:
    ds_read_b32 v13, v61
    s_waitcnt lgkmcnt(0)
    v_cmp_gt_u32 vcc, 5, v13
    s_cbranch_vccz L_ldwd_41
    s_sub_u32 s14, s14, 1
    s_cmp_lg_u32 s14, 0
    s_cbranch_scc1 L_ldw_40
L_ldwd_41:
L_ldok_39:
    v_mfma_f32_16x16x32_bf16 v[16:19], a[0:3], a[8:11], v[16:19]
    ds_read_b128 a[56:59], v56 offset:4096
    v_mfma_f32_16x16x32_bf16 v[36:39], a[4:7], a[8:11], v[36:39]
    ds_read_b128 a[60:63], v56 offset:6144
    v_mfma_f32_16x16x32_bf16 v[20:23], a[0:3], a[12:15], v[20:23]
    ds_read_b128 a[64:67], v58 offset:0
    v_mfma_f32_16x16x32_bf16 v[40:43], a[4:7], a[12:15], v[40:43]
    ds_read_b128 a[68:71], v58 offset:2048
    v_mfma_f32_16x16x32_bf16 v[24:27], a[0:3], a[16:19], v[24:27]
    ds_read_b128 a[72:75], v58 offset:4096
    v_mfma_f32_16x16x32_bf16 v[44:47], a[4:7], a[16:19], v[44:47]
    ds_read_b128 a[76:79], v58 offset:6144
    v_mfma_f32_16x16x32_bf16 v[28:31], a[0:3], a[20:23], v[28:31]
    ds_read_b128 a[80:83], v58 offset:8192
    v_mfma_f32_16x16x32_bf16 v[48:51], a[4:7], a[20:23], v[48:51]
    v_mfma_f32_16x16x32_bf16 v[32:35], a[0:3], a[24:27], v[32:35]
    v_mfma_f32_16x16x32_bf16 v[52:55], a[4:7], a[24:27], v[52:55]
    s_waitcnt lgkmcnt(8)
    s_cmp_ge_u32 s86, 4
    s_cselect_b32 s82, s80, s78
    s_cselect_b32 s83, s81, s79
    v_mfma_f32_16x16x32_bf16 v[16:19], a[28:31], a[36:39], v[16:19]
    v_mov_b32 v62, 4
    s_mov_b64 exec, 1
    ds_write_b32 v60, v62
    s_mov_b64 exec, -1
    s_add_u32 m0, s93, 4294966528
    v_mfma_f32_16x16x32_bf16 v[36:39], a[32:35], a[36:39], v[36:39]
    global_load_lds_dwordx4 v6, s[82:83] offset:768
    ds_read_b128 a[0:3], v57 offset:4096
    v_mfma_f32_16x16x32_bf16 v[20:23], a[28:31], a[40:43], v[20:23]
    ds_read_b128 a[4:7], v57 offset:6144
    v_mfma_f32_16x16x32_bf16 v[40:43], a[32:35], a[40:43], v[40:43]
    ds_read_b128 a[8:11], v59 offset:0
    s_add_u32 m0, s93, 256
    v_mfma_f32_16x16x32_bf16 v[24:27], a[28:31], a[44:47], v[24:27]
    global_load_lds_dwordx4 v7, s[82:83] offset:768
    ds_read_b128 a[12:15], v59 offset:2048
    v_mfma_f32_16x16x32_bf16 v[44:47], a[32:35], a[44:47], v[44:47]
    ds_read_b128 a[16:19], v59 offset:4096
    v_mfma_f32_16x16x32_bf16 v[28:31], a[28:31], a[48:51], v[28:31]
    ds_read_b128 a[20:23], v59 offset:6144
    s_add_u32 m0, s93, 1280
    v_mfma_f32_16x16x32_bf16 v[48:51], a[32:35], a[48:51], v[48:51]
    global_load_lds_dwordx4 v8, s[82:83] offset:768
    ds_read_b128 a[24:27], v59 offset:8192
    v_mfma_f32_16x16x32_bf16 v[32:35], a[28:31], a[52:55], v[32:35]
    ds_read_b32 v13, v61
    s_add_u32 m0, s93, 2304
    v_mfma_f32_16x16x32_bf16 v[52:55], a[32:35], a[52:55], v[52:55]
    global_load_lds_dwordx4 v9, s[82:83] offset:768
    s_waitcnt lgkmcnt(9)
    s_waitcnt lgkmcnt(0)
    s_waitcnt vmcnt(4)
    v_cmp_gt_u32 vcc, 6, v13
    s_cbranch_vccz L_ldok_42
    s_mov_b32 s14, 640000
L_ldw_43:
    ds_read_b32 v13, v61
    s_waitcnt lgkmcnt(0)
    v_cmp_gt_u32 vcc, 6, v13
    s_cbranch_vccz L_ldwd_44
    s_sub_u32 s14, s14, 1
    s_cmp_lg_u32 s14, 0
    s_cbranch_scc1 L_ldw_43
L_ldwd_44:
L_ldok_42:
    v_mfma_f32_16x16x32_bf16 v[16:19], a[56:59], a[64:67], v[16:19]
    ds_read_b128 a[28:31], v56 offset:8192
    v_mfma_f32_16x16x32_bf16 v[36:39], a[60:63], a[64:67], v[36:39]
    ds_read_b128 a[32:35], v56 offset:10240
    v_mfma_f32_16x16x32_bf16 v[20:23], a[56:59], a[68:71], v[20:23]
    ds_read_b128 a[36:39], v58 offset:10240
    v_mfma_f32_16x16x32_bf16 v[40:43], a[60:63], a[68:71], v[40:43]
    ds_read_b128 a[40:43], v58 offset:12288
    v_mfma_f32_16x16x32_bf16 v[24:27], a[56:59], a[72:75], v[24:27]
    ds_read_b128 a[44:47], v58 offset:14336
    v_mfma_f32_16x16x32_bf16 v[44:47], a[60:63], a[72:75], v[44:47]
    ds_read_b128 a[48:51], v58 offset:16384
    v_mfma_f32_16x16x32_bf16 v[28:31], a[56:59], a[76:79], v[28:31]
    ds_read_b128 a[52:55], v58 offset:18432
    v_mfma_f32_16x16x32_bf16 v[48:51], a[60:63], a[76:79], v[48:51]
    v_mfma_f32_16x16x32_bf16 v[32:35], a[56:59], a[80:83], v[32:35]
    v_mfma_f32_16x16x32_bf16 v[52:55], a[60:63], a[80:83], v[52:55]
    s_waitcnt lgkmcnt(8)
    s_cmp_ge_u32 s86, 3
    s_cselect_b32 s82, s80, s78
    s_cselect_b32 s83, s81, s79
    v_mfma_f32_16x16x32_bf16 v[16:19], a[0:3], a[8:11], v[16:19]
    v_mov_b32 v62, 5
    s_mov_b64 exec, 1
    ds_write_b32 v60, v62
    s_mov_b64 exec, -1
    s_add_u32 m0, s93, 3200
    v_mfma_f32_16x16x32_bf16 v[36:39], a[4:7], a[8:11], v[36:39]
    global_load_lds_dwordx4 v6, s[82:83] offset:896
    ds_read_b128 a[56:59], v57 offset:8192
    v_mfma_f32_16x16x32_bf16 v[20:23], a[0:3], a[12:15], v[20:23]
    ds_read_b128 a[60:63], v57 offset:10240
    v_mfma_f32_16x16x32_bf16 v[40:43], a[4:7], a[12:15], v[40:43]
    ds_read_b128 a[64:67], v59 offset:10240
    s_add_u32 m0, s93, 4224
    v_mfma_f32_16x16x32_bf16 v[24:27], a[0:3], a[16:19], v[24:27]
    global_load_lds_dwordx4 v7, s[82:83] offset:896
    ds_read_b128 a[68:71], v59 offset:12288
    v_mfma_f32_16x16x32_bf16 v[44:47], a[4:7], a[16:19], v[44:47]
    ds_read_b128 a[72:75], v59 offset:14336
    v_mfma_f32_16x16x32_bf16 v[28:31], a[0:3], a[20:23], v[28:31]
    ds_read_b128 a[76:79], v59 offset:16384
    s_add_u32 m0, s93, 5248
    v_mfma_f32_16x16x32_bf16 v[48:51], a[4:7], a[20:23], v[48:51]
    global_load_lds_dwordx4 v8, s[82:83] offset:896
    ds_read_b128 a[80:83], v59 offset:18432
    v_mfma_f32_16x16x32_bf16 v[32:35], a[0:3], a[24:27], v[32:35]
    ds_read_b32 v13, v61
    s_add_u32 m0, s93, 6272
    v_mfma_f32_16x16x32_bf16 v[52:55], a[4:7], a[24:27], v[52:55]
    global_load_lds_dwordx4 v9, s[82:83] offset:896
    s_waitcnt lgkmcnt(9)
    s_waitcnt lgkmcnt(0)
    s_waitcnt vmcnt(4)
    v_cmp_gt_u32 vcc, 7, v13
    s_cbranch_vccz L_ldok_45
    s_mov_b32 s14, 640000
L_ldw_46:
    ds_read_b32 v13, v61
    s_waitcnt lgkmcnt(0)
    v_cmp_gt_u32 vcc, 7, v13
    s_cbranch_vccz L_ldwd_47
    s_sub_u32 s14, s14, 1
    s_cmp_lg_u32 s14, 0
    s_cbranch_scc1 L_ldw_46
L_ldwd_47:
L_ldok_45:
    v_mfma_f32_16x16x32_bf16 v[16:19], a[28:31], a[36:39], v[16:19]
    ds_read_b128 a[0:3], v56 offset:0
    v_mfma_f32_16x16x32_bf16 v[36:39], a[32:35], a[36:39], v[36:39]
    ds_read_b128 a[4:7], v56 offset:2048
    v_mfma_f32_16x16x32_bf16 v[20:23], a[28:31], a[40:43], v[20:23]
    ds_read_b128 a[8:11], v58 offset:20480
    v_mfma_f32_16x16x32_bf16 v[40:43], a[32:35], a[40:43], v[40:43]
    ds_read_b128 a[12:15], v58 offset:22528
    v_mfma_f32_16x16x32_bf16 v[24:27], a[28:31], a[44:47], v[24:27]
    ds_read_b128 a[16:19], v58 offset:24576
    v_mfma_f32_16x16x32_bf16 v[44:47], a[32:35], a[44:47], v[44:47]
    ds_read_b128 a[20:23], v58 offset:26624
    v_mfma_f32_16x16x32_bf16 v[28:31], a[28:31], a[48:51], v[28:31]
    ds_read_b128 a[24:27], v58 offset:28672
    v_mfma_f32_16x16x32_bf16 v[48:51], a[32:35], a[48:51], v[48:51]
    v_mfma_f32_16x16x32_bf16 v[32:35], a[28:31], a[52:55], v[32:35]
    v_mfma_f32_16x16x32_bf16 v[52:55], a[32:35], a[52:55], v[52:55]
    s_waitcnt lgkmcnt(8)
    s_cmp_ge_u32 s86, 2
    s_cselect_b32 s82, s80, s78
    s_cselect_b32 s83, s81, s79
    v_mfma_f32_16x16x32_bf16 v[16:19], a[56:59], a[64:67], v[16:19]
    v_mov_b32 v62, 6
    s_mov_b64 exec, 1
    ds_write_b32 v60, v62
    s_mov_b64 exec, -1
    s_add_u32 m0, s93, 7168
    v_mfma_f32_16x16x32_bf16 v[36:39], a[60:63], a[64:67], v[36:39]
    global_load_lds_dwordx4 v6, s[82:83] offset:1024
    ds_read_b128 a[28:31], v57 offset:0
    v_mfma_f32_16x16x32_bf16 v[20:23], a[56:59], a[68:71], v[20:23]
    ds_read_b128 a[32:35], v57 offset:2048
    v_mfma_f32_16x16x32_bf16 v[40:43], a[60:63], a[68:71], v[40:43]
    ds_read_b128 a[36:39], v59 offset:20480
    s_add_u32 m0, s93, 8192
    v_mfma_f32_16x16x32_bf16 v[24:27], a[56:59], a[72:75], v[24:27]
    global_load_lds_dwordx4 v7, s[82:83] offset:1024
    ds_read_b128 a[40:43], v59 offset:22528
    v_mfma_f32_16x16x32_bf16 v[44:47], a[60:63], a[72:75], v[44:47]
    ds_read_b128 a[44:47], v59 offset:24576
    v_mfma_f32_16x16x32_bf16 v[28:31], a[56:59], a[76:79], v[28:31]
    ds_read_b128 a[48:51], v59 offset:26624
    s_add_u32 m0, s93, 9216
    v_mfma_f32_16x16x32_bf16 v[48:51], a[60:63], a[76:79], v[48:51]
    global_load_lds_dwordx4 v8, s[82:83] offset:1024
    ds_read_b128 a[52:55], v59 offset:28672
    v_mfma_f32_16x16x32_bf16 v[32:35], a[56:59], a[80:83], v[32:35]
    ds_read_b32 v13, v61
    s_add_u32 m0, s93, 10240
    v_mfma_f32_16x16x32_bf16 v[52:55], a[60:63], a[80:83], v[52:55]
    global_load_lds_dwordx4 v9, s[82:83] offset:1024
    s_waitcnt lgkmcnt(9)
    s_waitcnt lgkmcnt(0)
    s_waitcnt vmcnt(4)
    v_cmp_gt_u32 vcc, 8, v13
    s_cbranch_vccz L_ldok_48
    s_mov_b32 s14, 640000
L_ldw_49:
    ds_read_b32 v13, v61
    s_waitcnt lgkmcnt(0)
    v_cmp_gt_u32 vcc, 8, v13
    s_cbranch_vccz L_ldwd_50
    s_sub_u32 s14, s14, 1
    s_cmp_lg_u32 s14, 0
    s_cbranch_scc1 L_ldw_49
L_ldwd_50:
L_ldok_48:
    v_mfma_f32_16x16x32_bf16 v[16:19], a[0:3], a[8:11], v[16:19]
    ds_read_b128 a[56:59], v56 offset:4096
    v_mfma_f32_16x16x32_bf16 v[36:39], a[4:7], a[8:11], v[36:39]
    ds_read_b128 a[60:63], v56 offset:6144
    v_mfma_f32_16x16x32_bf16 v[20:23], a[0:3], a[12:15], v[20:23]
    ds_read_b128 a[64:67], v58 offset:30720
    v_mfma_f32_16x16x32_bf16 v[40:43], a[4:7], a[12:15], v[40:43]
    ds_read_b128 a[68:71], v58 offset:32768
    v_mfma_f32_16x16x32_bf16 v[24:27], a[0:3], a[16:19], v[24:27]
    ds_read_b128 a[72:75], v58 offset:34816
    v_mfma_f32_16x16x32_bf16 v[44:47], a[4:7], a[16:19], v[44:47]
    ds_read_b128 a[76:79], v58 offset:36864
    v_mfma_f32_16x16x32_bf16 v[28:31], a[0:3], a[20:23], v[28:31]
    ds_read_b128 a[80:83], v58 offset:38912
    v_mfma_f32_16x16x32_bf16 v[48:51], a[4:7], a[20:23], v[48:51]
    v_mfma_f32_16x16x32_bf16 v[32:35], a[0:3], a[24:27], v[32:35]
    v_mfma_f32_16x16x32_bf16 v[52:55], a[4:7], a[24:27], v[52:55]
    s_waitcnt lgkmcnt(8)
    s_cmp_ge_u32 s86, 1
    s_cselect_b32 s82, s80, s78
    s_cselect_b32 s83, s81, s79
    v_mfma_f32_16x16x32_bf16 v[16:19], a[28:31], a[36:39], v[16:19]
    ds_read_b128 a[0:3], v57 offset:4096
    s_add_u32 m0, s93, 4294966144
    v_mfma_f32_16x16x32_bf16 v[36:39], a[32:35], a[36:39], v[36:39]
    global_load_lds_dwordx4 v6, s[82:83] offset:1152
    ds_read_b128 a[4:7], v57 offset:6144
    v_mfma_f32_16x16x32_bf16 v[20:23], a[28:31], a[40:43], v[20:23]
    ds_read_b128 a[8:11], v59 offset:30720
    v_mfma_f32_16x16x32_bf16 v[40:43], a[32:35], a[40:43], v[40:43]
    ds_read_b128 a[12:15], v59 offset:32768
    s_add_u32 m0, s93, 4294967168
    v_mfma_f32_16x16x32_bf16 v[24:27], a[28:31], a[44:47], v[24:27]
    global_load_lds_dwordx4 v7, s[82:83] offset:1152
    ds_read_b128 a[16:19], v59 offset:34816
    v_mfma_f32_16x16x32_bf16 v[44:47], a[32:35], a[44:47], v[44:47]
    ds_read_b128 a[20:23], v59 offset:36864
    v_mfma_f32_16x16x32_bf16 v[28:31], a[28:31], a[48:51], v[28:31]
    ds_read_b128 a[24:27], v59 offset:38912
    s_add_u32 m0, s93, 896
    v_mfma_f32_16x16x32_bf16 v[48:51], a[32:35], a[48:51], v[48:51]
    global_load_lds_dwordx4 v8, s[82:83] offset:1152
    ds_read_b32 v13, v61
    v_mfma_f32_16x16x32_bf16 v[32:35], a[28:31], a[52:55], v[32:35]
    s_add_u32 m0, s93, 1920
    v_mfma_f32_16x16x32_bf16 v[52:55], a[32:35], a[52:55], v[52:55]
    global_load_lds_dwordx4 v9, s[82:83] offset:1152
    s_waitcnt lgkmcnt(8)
    s_waitcnt lgkmcnt(0)
    s_waitcnt vmcnt(4)
    v_cmp_gt_u32 vcc, 9, v13
    s_cbranch_vccz L_ldok_51
    s_mov_b32 s14, 640000
L_ldw_52:
    ds_read_b32 v13, v61
    s_waitcnt lgkmcnt(0)
    v_cmp_gt_u32 vcc, 9, v13
    s_cbranch_vccz L_ldwd_53
    s_sub_u32 s14, s14, 1
    s_cmp_lg_u32 s14, 0
    s_cbranch_scc1 L_ldw_52
L_ldwd_53:
L_ldok_51:
    v_mfma_f32_16x16x32_bf16 v[16:19], a[56:59], a[64:67], v[16:19]
    ds_read_b128 a[28:31], v56 offset:8192
    v_mfma_f32_16x16x32_bf16 v[36:39], a[60:63], a[64:67], v[36:39]
    ds_read_b128 a[32:35], v56 offset:10240
    v_mfma_f32_16x16x32_bf16 v[20:23], a[56:59], a[68:71], v[20:23]
    ds_read_b128 a[36:39], v58 offset:0
    v_mfma_f32_16x16x32_bf16 v[40:43], a[60:63], a[68:71], v[40:43]
    ds_read_b128 a[40:43], v58 offset:2048
    v_mfma_f32_16x16x32_bf16 v[24:27], a[56:59], a[72:75], v[24:27]
    ds_read_b128 a[44:47], v58 offset:4096
    v_mfma_f32_16x16x32_bf16 v[44:47], a[60:63], a[72:75], v[44:47]
    ds_read_b128 a[48:51], v58 offset:6144
    v_mfma_f32_16x16x32_bf16 v[28:31], a[56:59], a[76:79], v[28:31]
    ds_read_b128 a[52:55], v58 offset:8192
    v_mfma_f32_16x16x32_bf16 v[48:51], a[60:63], a[76:79], v[48:51]
    v_mfma_f32_16x16x32_bf16 v[32:35], a[56:59], a[80:83], v[32:35]
    v_mfma_f32_16x16x32_bf16 v[52:55], a[60:63], a[80:83], v[52:55]
    s_waitcnt lgkmcnt(8)
    v_mfma_f32_16x16x32_bf16 v[16:19], a[0:3], a[8:11], v[16:19]
    ds_read_b128 a[56:59], v57 offset:8192
    v_mfma_f32_16x16x32_bf16 v[36:39], a[4:7], a[8:11], v[36:39]
    ds_read_b128 a[60:63], v57 offset:10240
    v_mfma_f32_16x16x32_bf16 v[20:23], a[0:3], a[12:15], v[20:23]
    ds_read_b128 a[64:67], v59 offset:0
    v_mfma_f32_16x16x32_bf16 v[40:43], a[4:7], a[12:15], v[40:43]
    ds_read_b128 a[68:71], v59 offset:2048
    v_mfma_f32_16x16x32_bf16 v[24:27], a[0:3], a[16:19], v[24:27]
    ds_read_b128 a[72:75], v59 offset:4096
    v_mfma_f32_16x16x32_bf16 v[44:47], a[4:7], a[16:19], v[44:47]
    ds_read_b128 a[76:79], v59 offset:6144
    v_mfma_f32_16x16x32_bf16 v[28:31], a[0:3], a[20:23], v[28:31]
    ds_read_b128 a[80:83], v59 offset:8192
    v_mfma_f32_16x16x32_bf16 v[48:51], a[4:7], a[20:23], v[48:51]
    ds_read_b32 v13, v61
    v_mfma_f32_16x16x32_bf16 v[32:35], a[0:3], a[24:27], v[32:35]
    v_mfma_f32_16x16x32_bf16 v[52:55], a[4:7], a[24:27], v[52:55]
    s_waitcnt lgkmcnt(8)
    s_waitcnt lgkmcnt(0)
    s_waitcnt vmcnt(0)
    v_cmp_gt_u32 vcc, 10, v13
    s_cbranch_vccz L_ldok_54
    s_mov_b32 s14, 640000
L_ldw_55:
    ds_read_b32 v13, v61
    s_waitcnt lgkmcnt(0)
    v_cmp_gt_u32 vcc, 10, v13
    s_cbranch_vccz L_ldwd_56
    s_sub_u32 s14, s14, 1
    s_cmp_lg_u32 s14, 0
    s_cbranch_scc1 L_ldw_55
L_ldwd_56:
L_ldok_54:
    v_mfma_f32_16x16x32_bf16 v[16:19], a[28:31], a[36:39], v[16:19]
    ds_read_b128 a[0:3], v56 offset:0
    v_mfma_f32_16x16x32_bf16 v[36:39], a[32:35], a[36:39], v[36:39]
    ds_read_b128 a[4:7], v56 offset:2048
    v_mfma_f32_16x16x32_bf16 v[20:23], a[28:31], a[40:43], v[20:23]
    ds_read_b128 a[8:11], v58 offset:10240
    v_mfma_f32_16x16x32_bf16 v[40:43], a[32:35], a[40:43], v[40:43]
    ds_read_b128 a[12:15], v58 offset:12288
    v_mfma_f32_16x16x32_bf16 v[24:27], a[28:31], a[44:47], v[24:27]
    ds_read_b128 a[16:19], v58 offset:14336
    v_mfma_f32_16x16x32_bf16 v[44:47], a[32:35], a[44:47], v[44:47]
    ds_read_b128 a[20:23], v58 offset:16384
    v_mfma_f32_16x16x32_bf16 v[28:31], a[28:31], a[48:51], v[28:31]
    ds_read_b128 a[24:27], v58 offset:18432
    v_mfma_f32_16x16x32_bf16 v[48:51], a[32:35], a[48:51], v[48:51]
    v_mfma_f32_16x16x32_bf16 v[32:35], a[28:31], a[52:55], v[32:35]
    v_mfma_f32_16x16x32_bf16 v[52:55], a[32:35], a[52:55], v[52:55]
    s_waitcnt lgkmcnt(8)
    v_mfma_f32_16x16x32_bf16 v[16:19], a[56:59], a[64:67], v[16:19]
    ds_read_b128 a[28:31], v57 offset:0
    v_mfma_f32_16x16x32_bf16 v[36:39], a[60:63], a[64:67], v[36:39]
    ds_read_b128 a[32:35], v57 offset:2048
    v_mfma_f32_16x16x32_bf16 v[20:23], a[56:59], a[68:71], v[20:23]
    ds_read_b128 a[36:39], v59 offset:10240
    v_mfma_f32_16x16x32_bf16 v[40:43], a[60:63], a[68:71], v[40:43]
    ds_read_b128 a[40:43], v59 offset:12288
    v_mfma_f32_16x16x32_bf16 v[24:27], a[56:59], a[72:75], v[24:27]
    ds_read_b128 a[44:47], v59 offset:14336
    v_mfma_f32_16x16x32_bf16 v[44:47], a[60:63], a[72:75], v[44:47]
    ds_read_b128 a[48:51], v59 offset:16384
    v_mfma_f32_16x16x32_bf16 v[28:31], a[56:59], a[76:79], v[28:31]
    ds_read_b128 a[52:55], v59 offset:18432
    v_mfma_f32_16x16x32_bf16 v[48:51], a[60:63], a[76:79], v[48:51]
    v_mfma_f32_16x16x32_bf16 v[32:35], a[56:59], a[80:83], v[32:35]
    v_mfma_f32_16x16x32_bf16 v[52:55], a[60:63], a[80:83], v[52:55]
    s_waitcnt lgkmcnt(7)
    v_mfma_f32_16x16x32_bf16 v[16:19], a[0:3], a[8:11], v[16:19]
    v_mfma_f32_16x16x32_bf16 v[36:39], a[4:7], a[8:11], v[36:39]
    v_mfma_f32_16x16x32_bf16 v[20:23], a[0:3], a[12:15], v[20:23]
    v_mfma_f32_16x16x32_bf16 v[40:43], a[4:7], a[12:15], v[40:43]
    v_mfma_f32_16x16x32_bf16 v[24:27], a[0:3], a[16:19], v[24:27]
    v_mfma_f32_16x16x32_bf16 v[44:47], a[4:7], a[16:19], v[44:47]
    v_mfma_f32_16x16x32_bf16 v[28:31], a[0:3], a[20:23], v[28:31]
    v_mfma_f32_16x16x32_bf16 v[48:51], a[4:7], a[20:23], v[48:51]
    v_mfma_f32_16x16x32_bf16 v[32:35], a[0:3], a[24:27], v[32:35]
    v_mfma_f32_16x16x32_bf16 v[52:55], a[4:7], a[24:27], v[52:55]
    s_waitcnt lgkmcnt(0)
    v_mfma_f32_16x16x32_bf16 v[16:19], a[28:31], a[36:39], v[16:19]
    v_mfma_f32_16x16x32_bf16 v[36:39], a[32:35], a[36:39], v[36:39]
    v_mfma_f32_16x16x32_bf16 v[20:23], a[28:31], a[40:43], v[20:23]
    v_mfma_f32_16x16x32_bf16 v[40:43], a[32:35], a[40:43], v[40:43]
    v_mfma_f32_16x16x32_bf16 v[24:27], a[28:31], a[44:47], v[24:27]
    v_mfma_f32_16x16x32_bf16 v[44:47], a[32:35], a[44:47], v[44:47]
    v_mfma_f32_16x16x32_bf16 v[28:31], a[28:31], a[48:51], v[28:31]
    v_mfma_f32_16x16x32_bf16 v[48:51], a[32:35], a[48:51], v[48:51]
    v_mfma_f32_16x16x32_bf16 v[32:35], a[28:31], a[52:55], v[32:35]
    v_mfma_f32_16x16x32_bf16 v[52:55], a[32:35], a[52:55], v[52:55]
    s_nop 7
    s_nop 1
    v_fma_f32 v56, v90, v16, v17
    v_fma_f32 v57, v92, v20, v21
    v_fma_f32 v58, v94, v24, v25
    v_fma_f32 v59, v96, v28, v29
    v_fma_f32 v60, v98, v32, v33
    v_fmac_f32_dpp v56, v16, v91 row_ror:8 row_mask:0xf bank_mask:0xf
    v_fmac_f32_dpp v57, v20, v93 row_ror:8 row_mask:0xf bank_mask:0xf
    v_fmac_f32_dpp v58, v24, v95 row_ror:8 row_mask:0xf bank_mask:0xf
    v_fmac_f32_dpp v59, v28, v97 row_ror:8 row_mask:0xf bank_mask:0xf
    v_fmac_f32_dpp v60, v32, v99 row_ror:8 row_mask:0xf bank_mask:0xf
    v_fma_f32 v61, v90, v56, v18
    v_fma_f32 v62, v92, v57, v22
    v_fma_f32 v63, v94, v58, v26
    v_fma_f32 v64, v96, v59, v30
    v_fma_f32 v65, v98, v60, v34
    v_fmac_f32_dpp v61, v56, v91 row_ror:8 row_mask:0xf bank_mask:0xf
    v_fmac_f32_dpp v62, v57, v93 row_ror:8 row_mask:0xf bank_mask:0xf
    v_fmac_f32_dpp v63, v58, v95 row_ror:8 row_mask:0xf bank_mask:0xf
    v_fmac_f32_dpp v64, v59, v97 row_ror:8 row_mask:0xf bank_mask:0xf
    v_fmac_f32_dpp v65, v60, v99 row_ror:8 row_mask:0xf bank_mask:0xf
    v_fma_f32 v56, v90, v61, v19
    v_fma_f32 v57, v92, v62, v23
    v_fma_f32 v58, v94, v63, v27
    v_fma_f32 v59, v96, v64, v31
    v_fma_f32 v60, v98, v65, v35
    v_fmac_f32_dpp v56, v61, v91 row_ror:8 row_mask:0xf bank_mask:0xf
    v_fmac_f32_dpp v57, v62, v93 row_ror:8 row_mask:0xf bank_mask:0xf
    v_fmac_f32_dpp v58, v63, v95 row_ror:8 row_mask:0xf bank_mask:0xf
    v_fmac_f32_dpp v59, v64, v97 row_ror:8 row_mask:0xf bank_mask:0xf
    v_fmac_f32_dpp v60, v65, v99 row_ror:8 row_mask:0xf bank_mask:0xf
    v_fma_f32 v61, v90, v56, v36
    v_fma_f32 v62, v92, v57, v40
    v_fma_f32 v63, v94, v58, v44
    v_fma_f32 v64, v96, v59, v48
    v_fma_f32 v65, v98, v60, v52
    v_fmac_f32_dpp v61, v56, v91 row_ror:8 row_mask:0xf bank_mask:0xf
    v_fmac_f32_dpp v62, v57, v93 row_ror:8 row_mask:0xf bank_mask:0xf
    v_fmac_f32_dpp v63, v58, v95 row_ror:8 row_mask:0xf bank_mask:0xf
    v_fmac_f32_dpp v64, v59, v97 row_ror:8 row_mask:0xf bank_mask:0xf
    v_fmac_f32_dpp v65, v60, v99 row_ror:8 row_mask:0xf bank_mask:0xf
    v_fma_f32 v56, v90, v61, v37
    v_fma_f32 v57, v92, v62, v41
    v_fma_f32 v58, v94, v63, v45
    v_fma_f32 v59, v96, v64, v49
    v_fma_f32 v60, v98, v65, v53
    v_fmac_f32_dpp v56, v61, v91 row_ror:8 row_mask:0xf bank_mask:0xf
    v_fmac_f32_dpp v57, v62, v93 row_ror:8 row_mask:0xf bank_mask:0xf
    v_fmac_f32_dpp v58, v63, v95 row_ror:8 row_mask:0xf bank_mask:0xf
    v_fmac_f32_dpp v59, v64, v97 row_ror:8 row_mask:0xf bank_mask:0xf
    v_fmac_f32_dpp v60, v65, v99 row_ror:8 row_mask:0xf bank_mask:0xf
    v_fma_f32 v61, v90, v56, v38
    v_fma_f32 v62, v92, v57, v42
    v_fma_f32 v63, v94, v58, v46
    v_fma_f32 v64, v96, v59, v50
    v_fma_f32 v65, v98, v60, v54
    v_fmac_f32_dpp v61, v56, v91 row_ror:8 row_mask:0xf bank_mask:0xf
    v_fmac_f32_dpp v62, v57, v93 row_ror:8 row_mask:0xf bank_mask:0xf
    v_fmac_f32_dpp v63, v58, v95 row_ror:8 row_mask:0xf bank_mask:0xf
    v_fmac_f32_dpp v64, v59, v97 row_ror:8 row_mask:0xf bank_mask:0xf
    v_fmac_f32_dpp v65, v60, v99 row_ror:8 row_mask:0xf bank_mask:0xf
    v_fma_f32 v56, v90, v61, v39
    v_fma_f32 v57, v92, v62, v43
    v_fma_f32 v58, v94, v63, v47
    v_fma_f32 v59, v96, v64, v51
    v_fma_f32 v60, v98, v65, v55
    v_fmac_f32_dpp v56, v61, v91 row_ror:8 row_mask:0xf bank_mask:0xf
    v_fmac_f32_dpp v57, v62, v93 row_ror:8 row_mask:0xf bank_mask:0xf
    v_fmac_f32_dpp v58, v63, v95 row_ror:8 row_mask:0xf bank_mask:0xf
    v_fmac_f32_dpp v59, v64, v97 row_ror:8 row_mask:0xf bank_mask:0xf
    v_fmac_f32_dpp v60, v65, v99 row_ror:8 row_mask:0xf bank_mask:0xf
    s_mul_i32 s9, s3, 1280
    s_add_u32 s9, s9, 94208
    v_lshrrev_b32 v66, 4, v0
    v_and_b32 v67, 15, v0
    v_lshlrev_b32 v67, 2, v67
    v_mul_u32_u24 v68, 320, v66
    v_add_u32 v68, v68, v67
    v_add_u32 v68, s9, v68
    ds_write_b32 v68, v56 offset:0
    ds_write_b32 v68, v57 offset:64
    ds_write_b32 v68, v58 offset:128
    ds_write_b32 v68, v59 offset:192
    ds_write_b32 v68, v60 offset:256
    v_add_u32 v72, 163456, v67
    v_subrev_u32 v69, 320, v68
    v_cmp_gt_u32 vcc, 1, v66
    s_nop 1
    v_cndmask_b32 v69, v69, v72, vcc
    v_subrev_u32 v70, 640, v68
    v_cmp_gt_u32 vcc, 2, v66
    s_nop 1
    v_cndmask_b32 v70, v70, v72, vcc
    v_subrev_u32 v71, 960, v68
    v_cmp_gt_u32 vcc, 3, v66
    s_nop 1
    v_cndmask_b32 v71, v71, v72, vcc
    s_waitcnt lgkmcnt(0)
    ds_read_b32 v83, v71 offset:0
    ds_read_b32 v84, v71 offset:64
    ds_read_b32 v85, v71 offset:128
    ds_read_b32 v86, v71 offset:192
    ds_read_b32 v87, v71 offset:256
    ds_read_b32 v78, v70 offset:0
    ds_read_b32 v79, v70 offset:64
    ds_read_b32 v80, v70 offset:128
    ds_read_b32 v81, v70 offset:192
    ds_read_b32 v82, v70 offset:256
    ds_read_b32 v73, v69 offset:0
    ds_read_b32 v74, v69 offset:64
    ds_read_b32 v75, v69 offset:128
    ds_read_b32 v76, v69 offset:192
    ds_read_b32 v77, v69 offset:256
    s_waitcnt lgkmcnt(0)
    v_fma_f32 v61, v100, v83, v78
    v_fma_f32 v62, v102, v84, v79
    v_fma_f32 v63, v104, v85, v80
    v_fma_f32 v64, v106, v86, v81
    v_fma_f32 v65, v108, v87, v82
    v_fmac_f32_dpp v61, v83, v101 row_ror:8 row_mask:0xf bank_mask:0xf
    v_fmac_f32_dpp v62, v84, v103 row_ror:8 row_mask:0xf bank_mask:0xf
    v_fmac_f32_dpp v63, v85, v105 row_ror:8 row_mask:0xf bank_mask:0xf
    v_fmac_f32_dpp v64, v86, v107 row_ror:8 row_mask:0xf bank_mask:0xf
    v_fmac_f32_dpp v65, v87, v109 row_ror:8 row_mask:0xf bank_mask:0xf
    v_fma_f32 v73, v100, v61, v73
    v_fma_f32 v74, v102, v62, v74
    v_fma_f32 v75, v104, v63, v75
    v_fma_f32 v76, v106, v64, v76
    v_fma_f32 v77, v108, v65, v77
    v_fmac_f32_dpp v73, v61, v101 row_ror:8 row_mask:0xf bank_mask:0xf
    v_fmac_f32_dpp v74, v62, v103 row_ror:8 row_mask:0xf bank_mask:0xf
    v_fmac_f32_dpp v75, v63, v105 row_ror:8 row_mask:0xf bank_mask:0xf
    v_fmac_f32_dpp v76, v64, v107 row_ror:8 row_mask:0xf bank_mask:0xf
    v_fmac_f32_dpp v77, v65, v109 row_ror:8 row_mask:0xf bank_mask:0xf
    v_fma_f32 v78, v100, v73, v56
    v_fma_f32 v79, v102, v74, v57
    v_fma_f32 v80, v104, v75, v58
    v_fma_f32 v81, v106, v76, v59
    v_fma_f32 v82, v108, v77, v60
    v_fmac_f32_dpp v78, v73, v101 row_ror:8 row_mask:0xf bank_mask:0xf
    v_fmac_f32_dpp v79, v74, v103 row_ror:8 row_mask:0xf bank_mask:0xf
    v_fmac_f32_dpp v80, v75, v105 row_ror:8 row_mask:0xf bank_mask:0xf
    v_fmac_f32_dpp v81, v76, v107 row_ror:8 row_mask:0xf bank_mask:0xf
    v_fmac_f32_dpp v82, v77, v109 row_ror:8 row_mask:0xf bank_mask:0xf
    s_mul_i32 s9, s3, 320
    s_add_u32 s9, s9, 99328
    v_add_u32 v69, s9, v67
    v_add_u32 v70, 99328, v67
    s_mov_b32 exec_lo, 0x0
    s_mov_b32 exec_hi, 0xffff0000
    ds_write_b32 v69, v78 offset:0
    ds_write_b32 v69, v79 offset:64
    ds_write_b32 v69, v80 offset:128
    ds_write_b32 v69, v81 offset:192
    ds_write_b32 v69, v82 offset:256
    s_mov_b64 exec, -1
    s_waitcnt lgkmcnt(0)
    v_mov_b32 v13, 12
    s_mov_b64 exec, 1
    ds_write_b32 v14, v13
    s_mov_b64 exec, -1
    s_mov_b32 s14, 640000
L_s5w_57:
    ds_read_b32 v13, v15
    s_waitcnt lgkmcnt(0)
    v_cmp_gt_u32 vcc, 12, v13
    s_cbranch_vccz L_s5wd_58
    s_sub_u32 s14, s14, 1
    s_cmp_lg_u32 s14, 0
    s_cbranch_scc1 L_s5w_57
L_s5wd_58:
    v_mov_b32 v83, 0
    v_mov_b32 v84, 0
    v_mov_b32 v85, 0
    v_mov_b32 v86, 0
    v_mov_b32 v87, 0
    s_cmp_le_u32 s3, 0
    s_cbranch_scc1 L_cw_59
    ds_read_b32 v61, v70 offset:0
    ds_read_b32 v62, v70 offset:64
    ds_read_b32 v63, v70 offset:128
    ds_read_b32 v64, v70 offset:192
    ds_read_b32 v65, v70 offset:256
    s_waitcnt lgkmcnt(0)
    v_fma_f32 v61, v120, v83, v61
    v_fma_f32 v62, v122, v84, v62
    v_fma_f32 v63, v124, v85, v63
    v_fma_f32 v64, v126, v86, v64
    v_fma_f32 v65, v128, v87, v65
    v_fmac_f32_dpp v61, v83, v121 row_ror:8 row_mask:0xf bank_mask:0xf
    v_fmac_f32_dpp v62, v84, v123 row_ror:8 row_mask:0xf bank_mask:0xf
    v_fmac_f32_dpp v63, v85, v125 row_ror:8 row_mask:0xf bank_mask:0xf
    v_fmac_f32_dpp v64, v86, v127 row_ror:8 row_mask:0xf bank_mask:0xf
    v_fmac_f32_dpp v65, v87, v129 row_ror:8 row_mask:0xf bank_mask:0xf
    v_mov_b32 v83, v61
    v_mov_b32 v84, v62
    v_mov_b32 v85, v63
    v_mov_b32 v86, v64
    v_mov_b32 v87, v65
L_cw_59:
    s_cmp_le_u32 s3, 1
    s_cbranch_scc1 L_cw_60
    ds_read_b32 v61, v70 offset:320
    ds_read_b32 v62, v70 offset:384
    ds_read_b32 v63, v70 offset:448
    ds_read_b32 v64, v70 offset:512
    ds_read_b32 v65, v70 offset:576
    s_waitcnt lgkmcnt(0)
    v_fma_f32 v61, v120, v83, v61
    v_fma_f32 v62, v122, v84, v62
    v_fma_f32 v63, v124, v85, v63
    v_fma_f32 v64, v126, v86, v64
    v_fma_f32 v65, v128, v87, v65
    v_fmac_f32_dpp v61, v83, v121 row_ror:8 row_mask:0xf bank_mask:0xf
    v_fmac_f32_dpp v62, v84, v123 row_ror:8 row_mask:0xf bank_mask:0xf
    v_fmac_f32_dpp v63, v85, v125 row_ror:8 row_mask:0xf bank_mask:0xf
    v_fmac_f32_dpp v64, v86, v127 row_ror:8 row_mask:0xf bank_mask:0xf
    v_fmac_f32_dpp v65, v87, v129 row_ror:8 row_mask:0xf bank_mask:0xf
    v_mov_b32 v83, v61
    v_mov_b32 v84, v62
    v_mov_b32 v85, v63
    v_mov_b32 v86, v64
    v_mov_b32 v87, v65
L_cw_60:
    s_cmp_le_u32 s3, 2
    s_cbranch_scc1 L_cw_61
    ds_read_b32 v61, v70 offset:640
    ds_read_b32 v62, v70 offset:704
    ds_read_b32 v63, v70 offset:768
    ds_read_b32 v64, v70 offset:832
    ds_read_b32 v65, v70 offset:896
    s_waitcnt lgkmcnt(0)
    v_fma_f32 v61, v120, v83, v61
    v_fma_f32 v62, v122, v84, v62
    v_fma_f32 v63, v124, v85, v63
    v_fma_f32 v64, v126, v86, v64
    v_fma_f32 v65, v128, v87, v65
    v_fmac_f32_dpp v61, v83, v121 row_ror:8 row_mask:0xf bank_mask:0xf
    v_fmac_f32_dpp v62, v84, v123 row_ror:8 row_mask:0xf bank_mask:0xf
    v_fmac_f32_dpp v63, v85, v125 row_ror:8 row_mask:0xf bank_mask:0xf
    v_fmac_f32_dpp v64, v86, v127 row_ror:8 row_mask:0xf bank_mask:0xf
    v_fmac_f32_dpp v65, v87, v129 row_ror:8 row_mask:0xf bank_mask:0xf
    v_mov_b32 v83, v61
    v_mov_b32 v84, v62
    v_mov_b32 v85, v63
    v_mov_b32 v86, v64
    v_mov_b32 v87, v65
L_cw_61:
    s_nop 1
    s_cmp_lg_u32 s3, 3
    s_cbranch_scc1 L_epub_62
    v_fma_f32 v78, v120, v83, v78
    v_fma_f32 v79, v122, v84, v79
    v_fma_f32 v80, v124, v85, v80
    v_fma_f32 v81, v126, v86, v81
    v_fma_f32 v82, v128, v87, v82
    v_fmac_f32_dpp v78, v83, v121 row_ror:8 row_mask:0xf bank_mask:0xf
    v_fmac_f32_dpp v79, v84, v123 row_ror:8 row_mask:0xf bank_mask:0xf
    v_fmac_f32_dpp v80, v85, v125 row_ror:8 row_mask:0xf bank_mask:0xf
    v_fmac_f32_dpp v81, v86, v127 row_ror:8 row_mask:0xf bank_mask:0xf
    v_fmac_f32_dpp v82, v87, v129 row_ror:8 row_mask:0xf bank_mask:0xf
    s_lshl_b32 s9, s5, 4
    s_add_u32 s9, s9, s4
    s_mul_i32 s9, s9, 640
    s_add_u32 s9, s9, 65536
    v_lshlrev_b32 v69, 1, v67
    s_mov_b32 exec_lo, 0x0
    s_mov_b32 exec_hi, 0xffff0000
    v_mov_b32 v64, v78
    v_mov_b32 v65, s8
    buffer_store_dwordx2 v[64:65], v69, s[60:63], s9 offen offset:0 sc1
    s_nop 1
    v_mov_b32 v62, v79
    v_mov_b32 v63, s8
    buffer_store_dwordx2 v[62:63], v69, s[60:63], s9 offen offset:128 sc1
    s_nop 1
    v_mov_b32 v64, v80
    v_mov_b32 v65, s8
    buffer_store_dwordx2 v[64:65], v69, s[60:63], s9 offen offset:256 sc1
    s_nop 1
    v_mov_b32 v62, v81
    v_mov_b32 v63, s8
    buffer_store_dwordx2 v[62:63], v69, s[60:63], s9 offen offset:384 sc1
    s_nop 1
    v_mov_b32 v64, v82
    v_mov_b32 v65, s8
    buffer_store_dwordx2 v[64:65], v69, s[60:63], s9 offen offset:512 sc1
    s_nop 1
    s_mov_b64 exec, -1
L_epub_62:
    v_fma_f32 v73, v110, v83, v73
    v_fma_f32 v74, v112, v84, v74
    v_fma_f32 v75, v114, v85, v75
    v_fma_f32 v76, v116, v86, v76
    v_fma_f32 v77, v118, v87, v77
    v_fmac_f32_dpp v73, v83, v111 row_ror:8 row_mask:0xf bank_mask:0xf
    v_fmac_f32_dpp v74, v84, v113 row_ror:8 row_mask:0xf bank_mask:0xf
    v_fmac_f32_dpp v75, v85, v115 row_ror:8 row_mask:0xf bank_mask:0xf
    v_fmac_f32_dpp v76, v86, v117 row_ror:8 row_mask:0xf bank_mask:0xf
    v_fmac_f32_dpp v77, v87, v119 row_ror:8 row_mask:0xf bank_mask:0xf
    s_lshr_b32 s9, s3, 1
    s_cmp_eq_u32 s9, 0
    s_cselect_b32 s78, s26, s28
    s_cselect_b32 s79, s27, s29
    s_mul_i32 s9, s7, 102400
    s_and_b32 s10, s3, 1
    s_mul_i32 s10, s10, 640
    s_add_u32 s9, s9, s10
    s_add_u32 s78, s78, s9
    s_addc_u32 s79, s79, 0
    s_mul_i32 s93, s3, 24576
    s_add_u32 s93, s93, 4096
    s_and_b32 s91, s6, 3
    s_and_b32 s9, s2, 7
    s_add_u32 s91, s91, s9
    s_cmp_ge_u32 s91, 5
    s_cselect_b32 s9, 5, 0
    s_sub_u32 s91, s91, s9
    s_cmp_ge_u32 s91, 5
    s_cselect_b32 s9, 5, 0
    s_sub_u32 s91, s91, s9
    s_add_u32 s9, s91, 0
    s_cmp_ge_u32 s9, 5
    s_cselect_b32 s10, 5, 0
    s_sub_u32 s9, s9, s10
    s_lshl_b32 s9, s9, 7
    s_add_u32 s68, s78, s9
    s_addc_u32 s69, s79, 0
    s_add_u32 s9, s91, 1
    s_cmp_ge_u32 s9, 5
    s_cselect_b32 s10, 5, 0
    s_sub_u32 s9, s9, s10
    s_lshl_b32 s9, s9, 7
    s_add_u32 s70, s78, s9
    s_addc_u32 s71, s79, 0
    s_add_u32 s9, s91, 2
    s_cmp_ge_u32 s9, 5
    s_cselect_b32 s10, 5, 0
    s_sub_u32 s9, s9, s10
    s_lshl_b32 s9, s9, 7
    s_add_u32 s72, s78, s9
    s_addc_u32 s73, s79, 0
    s_add_u32 s9, s91, 3
    s_cmp_ge_u32 s9, 5
    s_cselect_b32 s10, 5, 0
    s_sub_u32 s9, s9, s10
    s_lshl_b32 s9, s9, 7
    s_add_u32 s74, s78, s9
    s_addc_u32 s75, s79, 0
    s_add_u32 s9, s91, 4
    s_cmp_ge_u32 s9, 5
    s_cselect_b32 s10, 5, 0
    s_sub_u32 s9, s9, s10
    s_lshl_b32 s9, s9, 7
    s_add_u32 s76, s78, s9
    s_addc_u32 s77, s79, 0
    v_and_b32 v4, 15, v0
    v_lshrrev_b32 v5, 4, v0
    v_and_b32 v6, 6, v4
    v_xor_b32 v5, v5, v6
    v_lshlrev_b32 v5, 4, v5
    v_lshlrev_b32 v4, 7, v4
    v_add_u32 v4, v4, v5
    v_add_u32 v1, s93, v4
    v_xor_b32 v2, 64, v1
    s_add_u32 s84, s68, 0
    s_addc_u32 s85, s69, 0
    s_add_u32 m0, s93, 0
    s_nop 0
    global_load_lds_dwordx4 v10, s[84:85]
    s_add_u32 s84, s68, 10240
    s_addc_u32 s85, s69, 0
    s_add_u32 m0, s93, 1024
    s_nop 0
    global_load_lds_dwordx4 v10, s[84:85]
    s_add_u32 s84, s68, 20480
    s_addc_u32 s85, s69, 0
    s_add_u32 m0, s93, 2048
    s_nop 0
    global_load_lds_dwordx4 v10, s[84:85]
    s_add_u32 s84, s68, 30720
    s_addc_u32 s85, s69, 0
    s_add_u32 m0, s93, 3072
    s_nop 0
    global_load_lds_dwordx4 v10, s[84:85]
    s_add_u32 s84, s68, 40960
    s_addc_u32 s85, s69, 0
    s_add_u32 m0, s93, 4096
    s_nop 0
    global_load_lds_dwordx4 v10, s[84:85]
    s_add_u32 s84, s68, 51200
    s_addc_u32 s85, s69, 0
    s_add_u32 m0, s93, 5120
    s_nop 0
    global_load_lds_dwordx4 v10, s[84:85]
    s_add_u32 s84, s68, 61440
    s_addc_u32 s85, s69, 0
    s_add_u32 m0, s93, 6144
    s_nop 0
    global_load_lds_dwordx4 v10, s[84:85]
    s_add_u32 s84, s68, 71680
    s_addc_u32 s85, s69, 0
    s_add_u32 m0, s93, 7168
    s_nop 0
    global_load_lds_dwordx4 v10, s[84:85]
    s_add_u32 s84, s68, 81920
    s_addc_u32 s85, s69, 0
    s_add_u32 m0, s93, 8192
    s_nop 0
    global_load_lds_dwordx4 v10, s[84:85]
    s_add_u32 s84, s68, 92160
    s_addc_u32 s85, s69, 0
    s_add_u32 m0, s93, 9216
    s_nop 0
    global_load_lds_dwordx4 v10, s[84:85]
    s_add_u32 s84, s70, 0
    s_addc_u32 s85, s71, 0
    s_add_u32 m0, s93, 10240
    s_nop 0
    global_load_lds_dwordx4 v10, s[84:85]
    s_add_u32 s84, s70, 10240
    s_addc_u32 s85, s71, 0
    s_add_u32 m0, s93, 11264
    s_nop 0
    global_load_lds_dwordx4 v10, s[84:85]
    s_add_u32 s84, s70, 20480
    s_addc_u32 s85, s71, 0
    s_add_u32 m0, s93, 12288
    s_nop 0
    global_load_lds_dwordx4 v10, s[84:85]
    s_add_u32 s84, s70, 30720
    s_addc_u32 s85, s71, 0
    s_add_u32 m0, s93, 13312
    s_nop 0
    global_load_lds_dwordx4 v10, s[84:85]
    s_add_u32 s84, s70, 40960
    s_addc_u32 s85, s71, 0
    s_add_u32 m0, s93, 14336
    s_nop 0
    global_load_lds_dwordx4 v10, s[84:85]
    s_add_u32 s84, s70, 51200
    s_addc_u32 s85, s71, 0
    s_add_u32 m0, s93, 15360
    s_nop 0
    global_load_lds_dwordx4 v10, s[84:85]
    s_lshl_b32 s9, s5, 4
    s_lshl_b32 s10, s3, 2
    s_add_u32 s9, s9, s10
    s_mul_i32 s9, s9, 640
    s_add_u32 s9, s9, 65536
    v_mul_u32_u24 v69, 640, v66
    v_lshlrev_b32 v70, 1, v67
    v_add_u32 v69, v69, v70
    s_cmp_eq_u64 s[94:95], 0
    s_cbranch_scc1 L_lbd_64
    s_add_u32 s12, s58, s9
    s_addc_u32 s13, s59, 0
    s_mov_b32 s14, 40000
    s_lshl_b32 s10, s3, 2
    s_sub_u32 s10, s4, s10
L_es_65:
    s_load_dword s16, s[12:13], 636 glc
    s_load_dword s17, s[12:13], 1276 glc
    s_load_dword s18, s[12:13], 1916 glc
    s_load_dword s19, s[12:13], 2556 glc
    s_waitcnt lgkmcnt(0)
    s_mov_b32 s15, 0
    s_xor_b32 s16, s16, s8
    s_cmp_gt_u32 s10, 0
    s_cselect_b32 s16, s16, 0
    s_or_b32 s15, s15, s16
    s_xor_b32 s17, s17, s8
    s_cmp_gt_u32 s10, 1
    s_cselect_b32 s17, s17, 0
    s_or_b32 s15, s15, s17
    s_xor_b32 s18, s18, s8
    s_cmp_gt_u32 s10, 2
    s_cselect_b32 s18, s18, 0
    s_or_b32 s15, s15, s18
    s_xor_b32 s19, s19, s8
    s_cmp_gt_u32 s10, 3
    s_cselect_b32 s19, s19, 0
    s_or_b32 s15, s15, s19
    s_cmp_eq_u32 s15, 0
    s_cbranch_scc1 L_esd_66
    s_sleep 1
    s_sub_u32 s14, s14, 1
    s_cmp_lg_u32 s14, 0
    s_cbranch_scc1 L_es_65
L_esd_66:
    s_mov_b32 s14, 40000
L_lb_63:
    buffer_load_dwordx2 v[56:57], v69, s[60:63], s9 offen offset:0 sc1
    buffer_load_dwordx2 v[58:59], v69, s[60:63], s9 offen offset:128 sc1
    buffer_load_dwordx2 v[60:61], v69, s[60:63], s9 offen offset:256 sc1
    buffer_load_dwordx2 v[62:63], v69, s[60:63], s9 offen offset:384 sc1
    buffer_load_dwordx2 v[64:65], v69, s[60:63], s9 offen offset:512 sc1
    s_waitcnt vmcnt(0)
    s_mov_b64 s[10:11], 0
    v_cmp_ne_u32 vcc, s8, v57
    s_or_b64 s[10:11], s[10:11], vcc
    v_cmp_ne_u32 vcc, s8, v59
    s_or_b64 s[10:11], s[10:11], vcc
    v_cmp_ne_u32 vcc, s8, v61
    s_or_b64 s[10:11], s[10:11], vcc
    v_cmp_ne_u32 vcc, s8, v63
    s_or_b64 s[10:11], s[10:11], vcc
    v_cmp_ne_u32 vcc, s8, v65
    s_or_b64 s[10:11], s[10:11], vcc
    s_and_b64 s[10:11], s[10:11], s[94:95]
    s_cmp_eq_u64 s[10:11], 0
    s_cbranch_scc1 L_lbd_64
    s_sleep 1
    s_sub_u32 s14, s14, 1
    s_cmp_lg_u32 s14, 0
    s_cbranch_scc1 L_lb_63
L_lbd_64:
    v_cndmask_b32 v56, 0, v56, s[94:95]
    v_mov_b32 v57, 0
    v_cndmask_b32 v58, 0, v58, s[94:95]
    v_mov_b32 v59, 0
    v_cndmask_b32 v60, 0, v60, s[94:95]
    v_mov_b32 v61, 0
    v_cndmask_b32 v62, 0, v62, s[94:95]
    v_mov_b32 v63, 0
    v_cndmask_b32 v64, 0, v64, s[94:95]
    v_mov_b32 v65, 0
    s_nop 1
    v_fma_f32 v57, v140, v56, v57
    v_fma_f32 v59, v142, v58, v59
    v_fma_f32 v61, v144, v60, v61
    v_fma_f32 v63, v146, v62, v63
    v_fma_f32 v65, v148, v64, v65
    v_fmac_f32_dpp v57, v56, v141 row_ror:8 row_mask:0xf bank_mask:0xf
    v_fmac_f32_dpp v59, v58, v143 row_ror:8 row_mask:0xf bank_mask:0xf
    v_fmac_f32_dpp v61, v60, v145 row_ror:8 row_mask:0xf bank_mask:0xf
    v_fmac_f32_dpp v63, v62, v147 row_ror:8 row_mask:0xf bank_mask:0xf
    v_fmac_f32_dpp v65, v64, v149 row_ror:8 row_mask:0xf bank_mask:0xf
    v_mov_b32 v56, v57
    v_mov_b32 v58, v59
    v_mov_b32 v60, v61
    v_mov_b32 v62, v63
    v_mov_b32 v64, v65
    s_nop 1
    v_permlane32_swap_b32 v56, v57
    v_permlane32_swap_b32 v58, v59
    v_permlane32_swap_b32 v60, v61
    v_permlane32_swap_b32 v62, v63
    v_permlane32_swap_b32 v64, v65
    v_add_f32 v56, v56, v57
    v_add_f32 v58, v58, v59
    v_add_f32 v60, v60, v61
    v_add_f32 v62, v62, v63
    v_add_f32 v64, v64, v65
    v_mov_b32 v57, v56
    v_mov_b32 v59, v58
    v_mov_b32 v61, v60
    v_mov_b32 v63, v62
    v_mov_b32 v65, v64
    s_nop 1
    v_permlane16_swap_b32 v56, v57
    v_permlane16_swap_b32 v58, v59
    v_permlane16_swap_b32 v60, v61
    v_permlane16_swap_b32 v62, v63
    v_permlane16_swap_b32 v64, v65
    v_add_f32 v56, v56, v57
    v_add_f32 v58, v58, v59
    v_add_f32 v60, v60, v61
    v_add_f32 v62, v62, v63
    v_add_f32 v64, v64, v65
    v_lshlrev_b32 v88, 2, v67
    s_lshl_b32 s9, s3, 2
    s_add_u32 s9, s9, 94208
    v_add_u32 v89, s9, v88
    v_add_u32 v88, 94208, v88
    s_mov_b32 exec_lo, 0xffff
    s_mov_b32 exec_hi, 0x0
    ds_write_b32 v89, v56 offset:0
    ds_write_b32 v89, v58 offset:256
    ds_write_b32 v89, v60 offset:512
    ds_write_b32 v89, v62 offset:768
    ds_write_b32 v89, v64 offset:1024
    s_mov_b64 exec, -1
    s_waitcnt lgkmcnt(0)
    v_mov_b32 v13, 13
    s_mov_b64 exec, 1
    ds_write_b32 v14, v13
    s_mov_b64 exec, -1
    s_mov_b32 s14, 640000
L_s5w_67:
    ds_read_b32 v13, v15
    s_waitcnt lgkmcnt(0)
    v_cmp_gt_u32 vcc, 13, v13
    s_cbranch_vccz L_s5wd_68
    s_sub_u32 s14, s14, 1
    s_cmp_lg_u32 s14, 0
    s_cbranch_scc1 L_s5w_67
L_s5wd_68:
    ds_read_b128 v[56:59], v88 offset:0
    ds_read_b128 v[60:63], v88 offset:256
    ds_read_b128 v[64:67], v88 offset:512
    ds_read_b128 v[68:71], v88 offset:768
    ds_read_b128 v[80:83], v88 offset:1024
    s_waitcnt lgkmcnt(0)
    v_add_f32 v56, v56, v57
    v_add_f32 v58, v58, v59
    v_add_f32 v60, v60, v61
    v_add_f32 v62, v62, v63
    v_add_f32 v64, v64, v65
    v_add_f32 v66, v66, v67
    v_add_f32 v68, v68, v69
    v_add_f32 v70, v70, v71
    v_add_f32 v80, v80, v81
    v_add_f32 v82, v82, v83
    v_add_f32 v56, v56, v58
    v_add_f32 v60, v60, v62
    v_add_f32 v64, v64, v66
    v_add_f32 v68, v68, v70
    v_add_f32 v72, v80, v82
    v_mov_b32 v57, 0
    v_mov_b32 v61, 0
    v_mov_b32 v65, 0
    v_mov_b32 v69, 0
    v_mov_b32 v58, 0
    s_nop 0
    v_fma_f32 v57, v130, v56, v57
    v_fma_f32 v61, v132, v60, v61
    v_fma_f32 v65, v134, v64, v65
    v_fma_f32 v69, v136, v68, v69
    v_fma_f32 v58, v138, v72, v58
    v_fmac_f32_dpp v57, v56, v131 row_ror:8 row_mask:0xf bank_mask:0xf
    v_fmac_f32_dpp v61, v60, v133 row_ror:8 row_mask:0xf bank_mask:0xf
    v_fmac_f32_dpp v65, v64, v135 row_ror:8 row_mask:0xf bank_mask:0xf
    v_fmac_f32_dpp v69, v68, v137 row_ror:8 row_mask:0xf bank_mask:0xf
    v_fmac_f32_dpp v58, v72, v139 row_ror:8 row_mask:0xf bank_mask:0xf
    s_nop 0
    v_fma_f32 v73, v110, v57, v73
    v_fma_f32 v74, v112, v61, v74
    v_fma_f32 v75, v114, v65, v75
    v_fma_f32 v76, v116, v69, v76
    v_fma_f32 v77, v118, v58, v77
    v_fmac_f32_dpp v73, v57, v111 row_ror:8 row_mask:0xf bank_mask:0xf
    v_fmac_f32_dpp v74, v61, v113 row_ror:8 row_mask:0xf bank_mask:0xf
    v_fmac_f32_dpp v75, v65, v115 row_ror:8 row_mask:0xf bank_mask:0xf
    v_fmac_f32_dpp v76, v69, v117 row_ror:8 row_mask:0xf bank_mask:0xf
    v_fmac_f32_dpp v77, v58, v119 row_ror:8 row_mask:0xf bank_mask:0xf
    v_fma_f32 v16, v90, v73, v16
    v_fma_f32 v20, v92, v74, v20
    v_fma_f32 v24, v94, v75, v24
    v_fma_f32 v28, v96, v76, v28
    v_fma_f32 v32, v98, v77, v32
    v_fmac_f32_dpp v16, v73, v91 row_ror:8 row_mask:0xf bank_mask:0xf
    v_fmac_f32_dpp v20, v74, v93 row_ror:8 row_mask:0xf bank_mask:0xf
    v_fmac_f32_dpp v24, v75, v95 row_ror:8 row_mask:0xf bank_mask:0xf
    v_fmac_f32_dpp v28, v76, v97 row_ror:8 row_mask:0xf bank_mask:0xf
    v_fmac_f32_dpp v32, v77, v99 row_ror:8 row_mask:0xf bank_mask:0xf
    v_fma_f32 v17, v90, v16, v17
    v_fma_f32 v21, v92, v20, v21
    v_fma_f32 v25, v94, v24, v25
    v_fma_f32 v29, v96, v28, v29
    v_fma_f32 v33, v98, v32, v33
    v_fmac_f32_dpp v17, v16, v91 row_ror:8 row_mask:0xf bank_mask:0xf
    v_fmac_f32_dpp v21, v20, v93 row_ror:8 row_mask:0xf bank_mask:0xf
    v_fmac_f32_dpp v25, v24, v95 row_ror:8 row_mask:0xf bank_mask:0xf
    v_fmac_f32_dpp v29, v28, v97 row_ror:8 row_mask:0xf bank_mask:0xf
    v_fmac_f32_dpp v33, v32, v99 row_ror:8 row_mask:0xf bank_mask:0xf
    v_fma_f32 v18, v90, v17, v18
    v_fma_f32 v22, v92, v21, v22
    v_fma_f32 v26, v94, v25, v26
    v_fma_f32 v30, v96, v29, v30
    v_fma_f32 v34, v98, v33, v34
    v_fmac_f32_dpp v18, v17, v91 row_ror:8 row_mask:0xf bank_mask:0xf
    v_fmac_f32_dpp v22, v21, v93 row_ror:8 row_mask:0xf bank_mask:0xf
    v_fmac_f32_dpp v26, v25, v95 row_ror:8 row_mask:0xf bank_mask:0xf
    v_fmac_f32_dpp v30, v29, v97 row_ror:8 row_mask:0xf bank_mask:0xf
    v_fmac_f32_dpp v34, v33, v99 row_ror:8 row_mask:0xf bank_mask:0xf
    v_fma_f32 v19, v90, v18, v19
    v_fma_f32 v23, v92, v22, v23
    v_fma_f32 v27, v94, v26, v27
    v_fma_f32 v31, v96, v30, v31
    v_fma_f32 v35, v98, v34, v35
    v_fmac_f32_dpp v19, v18, v91 row_ror:8 row_mask:0xf bank_mask:0xf
    v_fmac_f32_dpp v23, v22, v93 row_ror:8 row_mask:0xf bank_mask:0xf
    v_fmac_f32_dpp v27, v26, v95 row_ror:8 row_mask:0xf bank_mask:0xf
    v_fmac_f32_dpp v31, v30, v97 row_ror:8 row_mask:0xf bank_mask:0xf
    v_fmac_f32_dpp v35, v34, v99 row_ror:8 row_mask:0xf bank_mask:0xf
    v_fma_f32 v36, v90, v19, v36
    v_fma_f32 v40, v92, v23, v40
    v_fma_f32 v44, v94, v27, v44
    v_fma_f32 v48, v96, v31, v48
    v_fma_f32 v52, v98, v35, v52
    v_fmac_f32_dpp v36, v19, v91 row_ror:8 row_mask:0xf bank_mask:0xf
    v_fmac_f32_dpp v40, v23, v93 row_ror:8 row_mask:0xf bank_mask:0xf
    v_fmac_f32_dpp v44, v27, v95 row_ror:8 row_mask:0xf bank_mask:0xf
    v_fmac_f32_dpp v48, v31, v97 row_ror:8 row_mask:0xf bank_mask:0xf
    v_fmac_f32_dpp v52, v35, v99 row_ror:8 row_mask:0xf bank_mask:0xf
    v_fma_f32 v37, v90, v36, v37
    v_fma_f32 v41, v92, v40, v41
    v_fma_f32 v45, v94, v44, v45
    v_fma_f32 v49, v96, v48, v49
    v_fma_f32 v53, v98, v52, v53
    v_fmac_f32_dpp v37, v36, v91 row_ror:8 row_mask:0xf bank_mask:0xf
    v_fmac_f32_dpp v41, v40, v93 row_ror:8 row_mask:0xf bank_mask:0xf
    v_fmac_f32_dpp v45, v44, v95 row_ror:8 row_mask:0xf bank_mask:0xf
    v_fmac_f32_dpp v49, v48, v97 row_ror:8 row_mask:0xf bank_mask:0xf
    v_fmac_f32_dpp v53, v52, v99 row_ror:8 row_mask:0xf bank_mask:0xf
    v_fma_f32 v38, v90, v37, v38
    v_fma_f32 v42, v92, v41, v42
    v_fma_f32 v46, v94, v45, v46
    v_fma_f32 v50, v96, v49, v50
    v_fma_f32 v54, v98, v53, v54
    v_fmac_f32_dpp v38, v37, v91 row_ror:8 row_mask:0xf bank_mask:0xf
    v_fmac_f32_dpp v42, v41, v93 row_ror:8 row_mask:0xf bank_mask:0xf
    v_fmac_f32_dpp v46, v45, v95 row_ror:8 row_mask:0xf bank_mask:0xf
    v_fmac_f32_dpp v50, v49, v97 row_ror:8 row_mask:0xf bank_mask:0xf
    v_fmac_f32_dpp v54, v53, v99 row_ror:8 row_mask:0xf bank_mask:0xf
    v_fma_f32 v39, v90, v38, v39
    v_fma_f32 v43, v92, v42, v43
    v_fma_f32 v47, v94, v46, v47
    v_fma_f32 v51, v96, v50, v51
    v_fma_f32 v55, v98, v54, v55
    v_fmac_f32_dpp v39, v38, v91 row_ror:8 row_mask:0xf bank_mask:0xf
    v_fmac_f32_dpp v43, v42, v93 row_ror:8 row_mask:0xf bank_mask:0xf
    v_fmac_f32_dpp v47, v46, v95 row_ror:8 row_mask:0xf bank_mask:0xf
    v_fmac_f32_dpp v51, v50, v97 row_ror:8 row_mask:0xf bank_mask:0xf
    v_fmac_f32_dpp v55, v54, v99 row_ror:8 row_mask:0xf bank_mask:0xf
    s_mul_i32 s9, s3, 24576
    s_add_u32 s9, s9, 23552
    v_lshrrev_b32 v66, 4, v0
    v_and_b32 v67, 15, v0
    v_lshlrev_b32 v67, 2, v67
    v_lshlrev_b32 v69, 4, v67
    v_lshlrev_b32 v70, 4, v66
    v_add_u32 v69, v69, v70
    v_add_u32 v69, s9, v69
    v_mul_f32 v56, v150, v16
    v_mul_f32 v57, v150, v17
    v_mul_f32 v58, v150, v18
    v_mul_f32 v59, v150, v19
    v_mul_f32 v60, v150, v36
    v_mul_f32 v61, v150, v37
    v_mul_f32 v62, v150, v38
    v_mul_f32 v63, v150, v39
    v_fmac_f32_dpp v56, v16, v151 row_ror:8 row_mask:0xf bank_mask:0xf
    v_fmac_f32_dpp v57, v17, v151 row_ror:8 row_mask:0xf bank_mask:0xf
    v_fmac_f32_dpp v58, v18, v151 row_ror:8 row_mask:0xf bank_mask:0xf
    v_fmac_f32_dpp v59, v19, v151 row_ror:8 row_mask:0xf bank_mask:0xf
    v_fmac_f32_dpp v60, v36, v151 row_ror:8 row_mask:0xf bank_mask:0xf
    v_fmac_f32_dpp v61, v37, v151 row_ror:8 row_mask:0xf bank_mask:0xf
    v_fmac_f32_dpp v62, v38, v151 row_ror:8 row_mask:0xf bank_mask:0xf
    v_fmac_f32_dpp v63, v39, v151 row_ror:8 row_mask:0xf bank_mask:0xf
    v_cvt_pk_bf16_f32 v64, v56, v57
    v_cvt_pk_bf16_f32 v65, v58, v59
    v_cvt_pk_bf16_f32 v66, v60, v61
    v_cvt_pk_bf16_f32 v67, v62, v63
    ds_write_b128 v69, v[64:67] offset:0
    v_mul_f32 v74, v152, v20
    v_mul_f32 v75, v152, v21
    v_mul_f32 v76, v152, v22
    v_mul_f32 v77, v152, v23
    v_mul_f32 v78, v152, v40
    v_mul_f32 v79, v152, v41
    v_mul_f32 v80, v152, v42
    v_mul_f32 v81, v152, v43
    v_fmac_f32_dpp v74, v20, v153 row_ror:8 row_mask:0xf bank_mask:0xf
    v_fmac_f32_dpp v75, v21, v153 row_ror:8 row_mask:0xf bank_mask:0xf
    v_fmac_f32_dpp v76, v22, v153 row_ror:8 row_mask:0xf bank_mask:0xf
    v_fmac_f32_dpp v77, v23, v153 row_ror:8 row_mask:0xf bank_mask:0xf
    v_fmac_f32_dpp v78, v40, v153 row_ror:8 row_mask:0xf bank_mask:0xf
    v_fmac_f32_dpp v79, v41, v153 row_ror:8 row_mask:0xf bank_mask:0xf
    v_fmac_f32_dpp v80, v42, v153 row_ror:8 row_mask:0xf bank_mask:0xf
    v_fmac_f32_dpp v81, v43, v153 row_ror:8 row_mask:0xf bank_mask:0xf
    v_cvt_pk_bf16_f32 v82, v74, v75
    v_cvt_pk_bf16_f32 v83, v76, v77
    v_cvt_pk_bf16_f32 v84, v78, v79
    v_cvt_pk_bf16_f32 v85, v80, v81
    ds_write_b128 v69, v[82:85] offset:1024
    v_mul_f32 v56, v154, v24
    v_mul_f32 v57, v154, v25
    v_mul_f32 v58, v154, v26
    v_mul_f32 v59, v154, v27
    v_mul_f32 v60, v154, v44
    v_mul_f32 v61, v154, v45
    v_mul_f32 v62, v154, v46
    v_mul_f32 v63, v154, v47
    v_fmac_f32_dpp v56, v24, v155 row_ror:8 row_mask:0xf bank_mask:0xf
    v_fmac_f32_dpp v57, v25, v155 row_ror:8 row_mask:0xf bank_mask:0xf
    v_fmac_f32_dpp v58, v26, v155 row_ror:8 row_mask:0xf bank_mask:0xf
    v_fmac_f32_dpp v59, v27, v155 row_ror:8 row_mask:0xf bank_mask:0xf
    v_fmac_f32_dpp v60, v44, v155 row_ror:8 row_mask:0xf bank_mask:0xf
    v_fmac_f32_dpp v61, v45, v155 row_ror:8 row_mask:0xf bank_mask:0xf
    v_fmac_f32_dpp v62, v46, v155 row_ror:8 row_mask:0xf bank_mask:0xf
    v_fmac_f32_dpp v63, v47, v155 row_ror:8 row_mask:0xf bank_mask:0xf
    v_cvt_pk_bf16_f32 v64, v56, v57
    v_cvt_pk_bf16_f32 v65, v58, v59
    v_cvt_pk_bf16_f32 v66, v60, v61
    v_cvt_pk_bf16_f32 v67, v62, v63
    ds_write_b128 v69, v[64:67] offset:2048
    v_mul_f32 v74, v156, v28
    v_mul_f32 v75, v156, v29
    v_mul_f32 v76, v156, v30
    v_mul_f32 v77, v156, v31
    v_mul_f32 v78, v156, v48
    v_mul_f32 v79, v156, v49
    v_mul_f32 v80, v156, v50
    v_mul_f32 v81, v156, v51
    v_fmac_f32_dpp v74, v28, v157 row_ror:8 row_mask:0xf bank_mask:0xf
    v_fmac_f32_dpp v75, v29, v157 row_ror:8 row_mask:0xf bank_mask:0xf
    v_fmac_f32_dpp v76, v30, v157 row_ror:8 row_mask:0xf bank_mask:0xf
    v_fmac_f32_dpp v77, v31, v157 row_ror:8 row_mask:0xf bank_mask:0xf
    v_fmac_f32_dpp v78, v48, v157 row_ror:8 row_mask:0xf bank_mask:0xf
    v_fmac_f32_dpp v79, v49, v157 row_ror:8 row_mask:0xf bank_mask:0xf
    v_fmac_f32_dpp v80, v50, v157 row_ror:8 row_mask:0xf bank_mask:0xf
    v_fmac_f32_dpp v81, v51, v157 row_ror:8 row_mask:0xf bank_mask:0xf
    v_cvt_pk_bf16_f32 v82, v74, v75
    v_cvt_pk_bf16_f32 v83, v76, v77
    v_cvt_pk_bf16_f32 v84, v78, v79
    v_cvt_pk_bf16_f32 v85, v80, v81
    ds_write_b128 v69, v[82:85] offset:3072
    v_mul_f32 v56, v158, v32
    v_mul_f32 v57, v158, v33
    v_mul_f32 v58, v158, v34
    v_mul_f32 v59, v158, v35
    v_mul_f32 v60, v158, v52
    v_mul_f32 v61, v158, v53
    v_mul_f32 v62, v158, v54
    v_mul_f32 v63, v158, v55
    v_fmac_f32_dpp v56, v32, v159 row_ror:8 row_mask:0xf bank_mask:0xf
    v_fmac_f32_dpp v57, v33, v159 row_ror:8 row_mask:0xf bank_mask:0xf
    v_fmac_f32_dpp v58, v34, v159 row_ror:8 row_mask:0xf bank_mask:0xf
    v_fmac_f32_dpp v59, v35, v159 row_ror:8 row_mask:0xf bank_mask:0xf
    v_fmac_f32_dpp v60, v52, v159 row_ror:8 row_mask:0xf bank_mask:0xf
    v_fmac_f32_dpp v61, v53, v159 row_ror:8 row_mask:0xf bank_mask:0xf
    v_fmac_f32_dpp v62, v54, v159 row_ror:8 row_mask:0xf bank_mask:0xf
    v_fmac_f32_dpp v63, v55, v159 row_ror:8 row_mask:0xf bank_mask:0xf
    v_cvt_pk_bf16_f32 v64, v56, v57
    v_cvt_pk_bf16_f32 v65, v58, v59
    v_cvt_pk_bf16_f32 v66, v60, v61
    v_cvt_pk_bf16_f32 v67, v62, v63
    ds_write_b128 v69, v[64:67] offset:4096
    v_lshrrev_b32 v66, 4, v0
    v_and_b32 v67, 15, v0
    v_lshlrev_b32 v67, 2, v67
    v_and_b32 v70, 1, v66
    v_lshlrev_b32 v70, 9, v70
    v_bfe_u32 v71, v0, 2, 2
    v_lshlrev_b32 v71, 6, v71
    v_add_u32 v70, v70, v71
    v_lshrrev_b32 v71, 1, v66
    v_lshlrev_b32 v71, 5, v71
    v_add_u32 v70, v70, v71
    v_and_b32 v71, 3, v0
    v_lshlrev_b32 v71, 3, v71
    v_add_u32 v70, v70, v71
    v_add_u32 v70, s9, v70
    s_waitcnt lgkmcnt(0)
    ds_read_b64_tr_b16 v[16:17], v70 offset:0
    ds_read_b64_tr_b16 v[18:19], v70 offset:256
    ds_read_b64_tr_b16 v[20:21], v70 offset:1024
    ds_read_b64_tr_b16 v[22:23], v70 offset:1280
    ds_read_b64_tr_b16 v[24:25], v70 offset:2048
    ds_read_b64_tr_b16 v[26:27], v70 offset:2304
    ds_read_b64_tr_b16 v[28:29], v70 offset:3072
    ds_read_b64_tr_b16 v[30:31], v70 offset:3328
    ds_read_b64_tr_b16 v[32:33], v70 offset:4096
    ds_read_b64_tr_b16 v[34:35], v70 offset:4352
    v_lshrrev_b32 v71, 1, v66
    v_lshlrev_b32 v71, 1, v71
    v_and_b32 v72, 1, v66
    v_add_u32 v71, v71, v72
    v_mul_u32_u24 v71, 20480, v71
    v_lshlrev_b32 v72, 2, v67
    v_add_u32 v71, v71, v72
    s_lshl_b32 s9, s4, 2
    s_add_u32 s9, s9, s3
    s_mul_i32 s9, s9, 81920
    s_mul_i32 s10, s5, 1280
    s_add_u32 s9, s9, s10
    s_add_u32 s9, s9, 8388608
    s_add_u32 s86, s9, 8388608
    s_waitcnt lgkmcnt(8)
    buffer_store_dwordx4 v[16:19], v71, s[60:63], s86 offen offset:0
    s_waitcnt lgkmcnt(6)
    buffer_store_dwordx4 v[20:23], v71, s[60:63], s86 offen offset:256
    s_waitcnt lgkmcnt(4)
    buffer_store_dwordx4 v[24:27], v71, s[60:63], s86 offen offset:512
    s_waitcnt lgkmcnt(2)
    buffer_store_dwordx4 v[28:31], v71, s[60:63], s86 offen offset:768
    s_waitcnt lgkmcnt(0)
    buffer_store_dwordx4 v[32:35], v71, s[60:63], s86 offen offset:1024
    s_lshl_b32 s87, s4, 1
    s_lshr_b32 s10, s3, 1
    s_add_u32 s87, s87, s10
    s_lshl_b32 s87, s87, 4
    s_add_u32 s87, s87, s5
    s_lshl_b32 s87, s87, 1
    s_and_b32 s10, s3, 1
    s_add_u32 s87, s87, s10
    s_lshl_b32 s87, s87, 2
    s_getreg_b32 s88, hwreg(HW_REG_XCC_ID)
    s_and_b32 s88, s88, 15
    s_lshl_b32 s88, s88, 8
    s_or_b32 s88, s88, 0x1000
    s_xor_b32 s88, s88, s8
    s_waitcnt vmcnt(0)
    s_add_u32 s10, s87, 12288
    v_mov_b32 v56, s88
    v_mov_b32 v57, 0
    s_mov_b64 exec, 1
    buffer_store_dword v56, v57, s[60:63], s10 offen
    s_mov_b64 exec, -1
    v_mov_b32 v58, 163124
    s_mov_b32 s14, 640000
L_co_70:
    ds_read_b32 v59, v58
    s_waitcnt lgkmcnt(0)
    v_cmp_gt_u32 vcc, 1, v59
    s_cbranch_vccz L_cod_71
    s_sleep 1
    s_sub_u32 s14, s14, 1
    s_cmp_lg_u32 s14, 0
    s_cbranch_scc1 L_co_70
L_cod_71:
    v_readfirstlane_b32 s90, v59
    s_nop 0
    s_cmp_eq_u32 s90, 1
    s_cbranch_scc1 L_colo_69
    buffer_store_dwordx4 v[16:19], v71, s[60:63], s9 offen offset:0 sc1
    buffer_store_dwordx4 v[20:23], v71, s[60:63], s9 offen offset:256 sc1
    buffer_store_dwordx4 v[24:27], v71, s[60:63], s9 offen offset:512 sc1
    buffer_store_dwordx4 v[28:31], v71, s[60:63], s9 offen offset:768 sc1
    buffer_store_dwordx4 v[32:35], v71, s[60:63], s9 offen offset:1024 sc1
    s_waitcnt vmcnt(0)
    s_add_u32 s10, s87, 8192
    v_mov_b32 v56, s8
    v_mov_b32 v57, 0
    s_mov_b64 exec, 1
    buffer_store_dword v56, v57, s[60:63], s10 offen sc1
    s_mov_b64 exec, -1
L_colo_69:
    ds_read_b128 a[0:3], v1 offset:0
    ds_read_b128 a[4:7], v2 offset:0
    ds_read_b128 a[8:11], v1 offset:2048
    ds_read_b128 a[12:15], v2 offset:2048
    ds_read_b128 a[16:19], v1 offset:4096
    ds_read_b128 a[20:23], v2 offset:4096
    ds_read_b128 a[24:27], v1 offset:6144
    ds_read_b128 a[28:31], v2 offset:6144
    s_waitcnt lgkmcnt(0)
    ds_read_b128 a[32:35], v1 offset:8192
    ds_read_b128 a[36:39], v2 offset:8192
    ds_read_b128 a[40:43], v1 offset:10240
    ds_read_b128 a[44:47], v2 offset:10240
    ds_read_b128 a[48:51], v1 offset:12288
    ds_read_b128 a[52:55], v2 offset:12288
    ds_read_b128 a[56:59], v1 offset:14336
    ds_read_b128 a[60:63], v2 offset:14336
    s_waitcnt lgkmcnt(0)
    s_add_u32 s84, s70, 61440
    s_addc_u32 s85, s71, 0
    s_add_u32 m0, s93, 0
    s_nop 0
    global_load_lds_dwordx4 v10, s[84:85]
    s_add_u32 s84, s70, 71680
    s_addc_u32 s85, s71, 0
    s_add_u32 m0, s93, 1024
    s_nop 0
    global_load_lds_dwordx4 v10, s[84:85]
    s_add_u32 s84, s70, 81920
    s_addc_u32 s85, s71, 0
    s_add_u32 m0, s93, 2048
    s_nop 0
    global_load_lds_dwordx4 v10, s[84:85]
    s_add_u32 s84, s70, 92160
    s_addc_u32 s85, s71, 0
    s_add_u32 m0, s93, 3072
    s_nop 0
    global_load_lds_dwordx4 v10, s[84:85]
    s_add_u32 s84, s72, 0
    s_addc_u32 s85, s73, 0
    s_add_u32 m0, s93, 4096
    s_nop 0
    global_load_lds_dwordx4 v10, s[84:85]
    s_add_u32 s84, s72, 10240
    s_addc_u32 s85, s73, 0
    s_add_u32 m0, s93, 5120
    s_nop 0
    global_load_lds_dwordx4 v10, s[84:85]
    s_add_u32 s84, s72, 20480
    s_addc_u32 s85, s73, 0
    s_add_u32 m0, s93, 6144
    s_nop 0
    global_load_lds_dwordx4 v10, s[84:85]
    s_add_u32 s84, s72, 30720
    s_addc_u32 s85, s73, 0
    s_add_u32 m0, s93, 7168
    s_nop 0
    global_load_lds_dwordx4 v10, s[84:85]
    s_add_u32 s84, s72, 40960
    s_addc_u32 s85, s73, 0
    s_add_u32 m0, s93, 8192
    s_nop 0
    global_load_lds_dwordx4 v10, s[84:85]
    s_add_u32 s84, s72, 51200
    s_addc_u32 s85, s73, 0
    s_add_u32 m0, s93, 9216
    s_nop 0
    global_load_lds_dwordx4 v10, s[84:85]
    s_add_u32 s84, s72, 61440
    s_addc_u32 s85, s73, 0
    s_add_u32 m0, s93, 10240
    s_nop 0
    global_load_lds_dwordx4 v10, s[84:85]
    s_add_u32 s84, s72, 71680
    s_addc_u32 s85, s73, 0
    s_add_u32 m0, s93, 11264
    s_nop 0
    global_load_lds_dwordx4 v10, s[84:85]
    s_add_u32 s84, s76, 0
    s_addc_u32 s85, s77, 0
    s_add_u32 m0, s93, 12288
    s_nop 0
    global_load_lds_dwordx4 v10, s[84:85]
    s_add_u32 s84, s76, 10240
    s_addc_u32 s85, s77, 0
    s_add_u32 m0, s93, 13312
    s_nop 0
    global_load_lds_dwordx4 v10, s[84:85]
    s_add_u32 s84, s76, 20480
    s_addc_u32 s85, s77, 0
    s_add_u32 m0, s93, 14336
    s_nop 0
    global_load_lds_dwordx4 v10, s[84:85]
    s_add_u32 s84, s76, 30720
    s_addc_u32 s85, s77, 0
    s_add_u32 m0, s93, 15360
    s_nop 0
    global_load_lds_dwordx4 v10, s[84:85]
    s_waitcnt vmcnt(0)
    ds_read_b128 a[64:67], v1 offset:0
    ds_read_b128 a[68:71], v2 offset:0
    ds_read_b128 a[72:75], v1 offset:2048
    ds_read_b128 a[76:79], v2 offset:2048
    ds_read_b128 a[80:83], v1 offset:4096
    ds_read_b128 a[84:87], v2 offset:4096
    ds_read_b128 a[88:91], v1 offset:6144
    ds_read_b128 a[92:95], v2 offset:6144
    ds_read_b128 v[96:99], v1 offset:8192
    ds_read_b128 v[100:103], v2 offset:8192
    ds_read_b128 v[104:107], v1 offset:10240
    ds_read_b128 v[108:111], v2 offset:10240
    s_waitcnt lgkmcnt(0)
    s_add_u32 s84, s72, 81920
    s_addc_u32 s85, s73, 0
    s_add_u32 m0, s93, 0
    s_nop 0
    global_load_lds_dwordx4 v10, s[84:85]
    s_add_u32 s84, s72, 92160
    s_addc_u32 s85, s73, 0
    s_add_u32 m0, s93, 1024
    s_nop 0
    global_load_lds_dwordx4 v10, s[84:85]
    s_add_u32 s84, s74, 0
    s_addc_u32 s85, s75, 0
    s_add_u32 m0, s93, 2048
    s_nop 0
    global_load_lds_dwordx4 v10, s[84:85]
    s_add_u32 s84, s74, 10240
    s_addc_u32 s85, s75, 0
    s_add_u32 m0, s93, 3072
    s_nop 0
    global_load_lds_dwordx4 v10, s[84:85]
    s_add_u32 s84, s74, 20480
    s_addc_u32 s85, s75, 0
    s_add_u32 m0, s93, 4096
    s_nop 0
    global_load_lds_dwordx4 v10, s[84:85]
    s_add_u32 s84, s74, 30720
    s_addc_u32 s85, s75, 0
    s_add_u32 m0, s93, 5120
    s_nop 0
    global_load_lds_dwordx4 v10, s[84:85]
    s_add_u32 s84, s74, 40960
    s_addc_u32 s85, s75, 0
    s_add_u32 m0, s93, 6144
    s_nop 0
    global_load_lds_dwordx4 v10, s[84:85]
    s_add_u32 s84, s74, 51200
    s_addc_u32 s85, s75, 0
    s_add_u32 m0, s93, 7168
    s_nop 0
    global_load_lds_dwordx4 v10, s[84:85]
    s_add_u32 s84, s74, 61440
    s_addc_u32 s85, s75, 0
    s_add_u32 m0, s93, 8192
    s_nop 0
    global_load_lds_dwordx4 v10, s[84:85]
    s_add_u32 s84, s74, 71680
    s_addc_u32 s85, s75, 0
    s_add_u32 m0, s93, 9216
    s_nop 0
    global_load_lds_dwordx4 v10, s[84:85]
    s_add_u32 s84, s74, 81920
    s_addc_u32 s85, s75, 0
    s_add_u32 m0, s93, 10240
    s_nop 0
    global_load_lds_dwordx4 v10, s[84:85]
    s_add_u32 s84, s74, 92160
    s_addc_u32 s85, s75, 0
    s_add_u32 m0, s93, 11264
    s_nop 0
    global_load_lds_dwordx4 v10, s[84:85]
    s_add_u32 s84, s76, 40960
    s_addc_u32 s85, s77, 0
    s_add_u32 m0, s93, 16384
    s_nop 0
    global_load_lds_dwordx4 v10, s[84:85]
    s_add_u32 s84, s76, 51200
    s_addc_u32 s85, s77, 0
    s_add_u32 m0, s93, 17408
    s_nop 0
    global_load_lds_dwordx4 v10, s[84:85]
    s_add_u32 s84, s76, 61440
    s_addc_u32 s85, s77, 0
    s_add_u32 m0, s93, 18432
    s_nop 0
    global_load_lds_dwordx4 v10, s[84:85]
    s_add_u32 s84, s76, 71680
    s_addc_u32 s85, s77, 0
    s_add_u32 m0, s93, 19456
    s_nop 0
    global_load_lds_dwordx4 v10, s[84:85]
    s_add_u32 s84, s76, 81920
    s_addc_u32 s85, s77, 0
    s_add_u32 m0, s93, 20480
    s_nop 0
    global_load_lds_dwordx4 v10, s[84:85]
    s_add_u32 s84, s76, 92160
    s_addc_u32 s85, s77, 0
    s_add_u32 m0, s93, 21504
    s_nop 0
    global_load_lds_dwordx4 v10, s[84:85]
    s_lshl_b32 s9, s6, 7
    s_add_u32 s12, s58, s9
    s_addc_u32 s13, s59, 0
    s_mov_b32 s89, 8388608
    s_mov_b32 s14, 40000
L_ph_72:
    s_load_dwordx16 s[16:31], s[12:13], 12288 glc
    s_load_dwordx16 s[32:47], s[12:13], 12352 glc
    s_mov_b32 s10, s88
    s_mov_b32 s11, s88
    s_waitcnt lgkmcnt(0)
    s_xor_b64 s[16:17], s[16:17], s[10:11]
    s_xor_b64 s[18:19], s[18:19], s[10:11]
    s_xor_b64 s[20:21], s[20:21], s[10:11]
    s_xor_b64 s[22:23], s[22:23], s[10:11]
    s_xor_b64 s[24:25], s[24:25], s[10:11]
    s_xor_b64 s[26:27], s[26:27], s[10:11]
    s_xor_b64 s[28:29], s[28:29], s[10:11]
    s_xor_b64 s[30:31], s[30:31], s[10:11]
    s_xor_b64 s[32:33], s[32:33], s[10:11]
    s_xor_b64 s[34:35], s[34:35], s[10:11]
    s_xor_b64 s[36:37], s[36:37], s[10:11]
    s_xor_b64 s[38:39], s[38:39], s[10:11]
    s_xor_b64 s[40:41], s[40:41], s[10:11]
    s_xor_b64 s[42:43], s[42:43], s[10:11]
    s_xor_b64 s[44:45], s[44:45], s[10:11]
    s_xor_b64 s[46:47], s[46:47], s[10:11]
    s_or_b64 s[16:17], s[16:17], s[18:19]
    s_or_b64 s[16:17], s[16:17], s[20:21]
    s_or_b64 s[16:17], s[16:17], s[22:23]
    s_or_b64 s[16:17], s[16:17], s[24:25]
    s_or_b64 s[16:17], s[16:17], s[26:27]
    s_or_b64 s[16:17], s[16:17], s[28:29]
    s_or_b64 s[16:17], s[16:17], s[30:31]
    s_or_b64 s[16:17], s[16:17], s[32:33]
    s_or_b64 s[16:17], s[16:17], s[34:35]
    s_or_b64 s[16:17], s[16:17], s[36:37]
    s_or_b64 s[16:17], s[16:17], s[38:39]
    s_or_b64 s[16:17], s[16:17], s[40:41]
    s_or_b64 s[16:17], s[16:17], s[42:43]
    s_or_b64 s[16:17], s[16:17], s[44:45]
    s_or_b64 s[16:17], s[16:17], s[46:47]
    s_or_b32 s15, s16, s17
    s_cmp_eq_u32 s15, 0
    s_cbranch_scc1 L_phf_74
    s_and_b32 s15, s14, 7
    s_cmp_lg_u32 s15, 0
    s_cbranch_scc1 L_ph_72_n
    s_load_dwordx16 s[16:31], s[12:13], 8192 glc
    s_load_dwordx16 s[32:47], s[12:13], 8256 glc
    s_mov_b32 s10, s8
    s_mov_b32 s11, s8
    s_waitcnt lgkmcnt(0)
    s_xor_b64 s[16:17], s[16:17], s[10:11]
    s_xor_b64 s[18:19], s[18:19], s[10:11]
    s_xor_b64 s[20:21], s[20:21], s[10:11]
    s_xor_b64 s[22:23], s[22:23], s[10:11]
    s_xor_b64 s[24:25], s[24:25], s[10:11]
    s_xor_b64 s[26:27], s[26:27], s[10:11]
    s_xor_b64 s[28:29], s[28:29], s[10:11]
    s_xor_b64 s[30:31], s[30:31], s[10:11]
    s_xor_b64 s[32:33], s[32:33], s[10:11]
    s_xor_b64 s[34:35], s[34:35], s[10:11]
    s_xor_b64 s[36:37], s[36:37], s[10:11]
    s_xor_b64 s[38:39], s[38:39], s[10:11]
    s_xor_b64 s[40:41], s[40:41], s[10:11]
    s_xor_b64 s[42:43], s[42:43], s[10:11]
    s_xor_b64 s[44:45], s[44:45], s[10:11]
    s_xor_b64 s[46:47], s[46:47], s[10:11]
    s_or_b64 s[16:17], s[16:17], s[18:19]
    s_or_b64 s[16:17], s[16:17], s[20:21]
    s_or_b64 s[16:17], s[16:17], s[22:23]
    s_or_b64 s[16:17], s[16:17], s[24:25]
    s_or_b64 s[16:17], s[16:17], s[26:27]
    s_or_b64 s[16:17], s[16:17], s[28:29]
    s_or_b64 s[16:17], s[16:17], s[30:31]
    s_or_b64 s[16:17], s[16:17], s[32:33]
    s_or_b64 s[16:17], s[16:17], s[34:35]
    s_or_b64 s[16:17], s[16:17], s[36:37]
    s_or_b64 s[16:17], s[16:17], s[38:39]
    s_or_b64 s[16:17], s[16:17], s[40:41]
    s_or_b64 s[16:17], s[16:17], s[42:43]
    s_or_b64 s[16:17], s[16:17], s[44:45]
    s_or_b64 s[16:17], s[16:17], s[46:47]
    s_or_b32 s15, s16, s17
    s_cmp_eq_u32 s15, 0
    s_cbranch_scc1 L_phd_73
L_ph_72_n:
    s_sub_u32 s14, s14, 1
    s_cmp_lg_u32 s14, 0
    s_cbranch_scc1 L_ph_72
    s_branch L_phd_73
L_phf_74:
    s_mov_b32 s89, 16777216
L_phd_73:
    s_cmp_lg_u32 s6, 31
    s_cbranch_scc1 L_nu_75
    s_cmp_lg_u32 s7, 0
    s_cbranch_scc1 L_nu_75
    s_cmp_lg_u32 s3, 0
    s_cbranch_scc1 L_nu_75
    v_mov_b32 v4, 0
    v_mov_b32 v5, s8
    s_mov_b64 exec, 1
    buffer_store_dword v5, v4, s[60:63], 0 offen sc1
    s_mov_b64 exec, -1
L_nu_75:
    s_lshl_b32 s9, s6, 3
    s_lshr_b32 s10, s3, 1
    s_add_u32 s9, s9, s10
    s_mul_i32 s9, s9, 20480
    s_and_b32 s10, s3, 1
    s_mul_i32 s10, s10, 10240
    s_add_u32 s9, s9, s10
    s_add_u32 s80, s9, s89
    s_lshl_b32 s92, s91, 1
    s_lshl_b32 s9, s92, 10
    s_add_u32 s80, s80, s9
    s_add_u32 s81, s80, 40960
    s_add_u32 s82, s80, 81920
    s_add_u32 s83, s80, 122880
    s_sub_u32 s68, s80, 10240
    s_sub_u32 s69, s81, 10240
    s_sub_u32 s70, s82, 10240
    s_sub_u32 s71, s83, 10240
    v_lshlrev_b32 v3, 4, v0
    s_cmp_eq_u32 s89, 8388608
    s_cbranch_scc1 L_g2slow_76
    s_cmp_ge_u32 s92, 10
    s_cselect_b32 s84, s68, s80
    s_add_u32 s84, s84, 0
    buffer_load_dwordx4 v[112:115], v3, s[60:63], s84 offen
    s_cmp_ge_u32 s92, 10
    s_cselect_b32 s84, s69, s81
    s_add_u32 s84, s84, 0
    buffer_load_dwordx4 v[116:119], v3, s[60:63], s84 offen
    s_cmp_ge_u32 s92, 10
    s_cselect_b32 s84, s70, s82
    s_add_u32 s84, s84, 0
    buffer_load_dwordx4 v[120:123], v3, s[60:63], s84 offen
    s_cmp_ge_u32 s92, 10
    s_cselect_b32 s84, s71, s83
    s_add_u32 s84, s84, 0
    buffer_load_dwordx4 v[124:127], v3, s[60:63], s84 offen
    s_cmp_ge_u32 s92, 9
    s_cselect_b32 s84, s68, s80
    s_add_u32 s84, s84, 1024
    buffer_load_dwordx4 v[128:131], v3, s[60:63], s84 offen
    s_cmp_ge_u32 s92, 9
    s_cselect_b32 s84, s69, s81
    s_add_u32 s84, s84, 1024
    buffer_load_dwordx4 v[132:135], v3, s[60:63], s84 offen
    s_cmp_ge_u32 s92, 9
    s_cselect_b32 s84, s70, s82
    s_add_u32 s84, s84, 1024
    buffer_load_dwordx4 v[136:139], v3, s[60:63], s84 offen
    s_cmp_ge_u32 s92, 9
    s_cselect_b32 s84, s71, s83
    s_add_u32 s84, s84, 1024
    buffer_load_dwordx4 v[140:143], v3, s[60:63], s84 offen
    s_cmp_ge_u32 s92, 8
    s_cselect_b32 s84, s68, s80
    s_add_u32 s84, s84, 2048
    buffer_load_dwordx4 v[144:147], v3, s[60:63], s84 offen
    s_cmp_ge_u32 s92, 8
    s_cselect_b32 s84, s69, s81
    s_add_u32 s84, s84, 2048
    buffer_load_dwordx4 v[148:151], v3, s[60:63], s84 offen
    s_cmp_ge_u32 s92, 8
    s_cselect_b32 s84, s70, s82
    s_add_u32 s84, s84, 2048
    buffer_load_dwordx4 v[152:155], v3, s[60:63], s84 offen
    s_cmp_ge_u32 s92, 8
    s_cselect_b32 s84, s71, s83
    s_add_u32 s84, s84, 2048
    buffer_load_dwordx4 v[156:159], v3, s[60:63], s84 offen
    s_waitcnt vmcnt(8) lgkmcnt(0)
    v_mfma_f32_16x16x32_bf16 v[16:19], v[112:115], a[0:3], 0
    v_mfma_f32_16x16x32_bf16 v[20:23], v[112:115], a[8:11], 0
    v_mfma_f32_16x16x32_bf16 v[24:27], v[112:115], a[16:19], 0
    v_mfma_f32_16x16x32_bf16 v[28:31], v[112:115], a[24:27], 0
    v_mfma_f32_16x16x32_bf16 v[32:35], v[112:115], a[32:35], 0
    v_mfma_f32_16x16x32_bf16 v[36:39], v[116:119], a[0:3], 0
    s_cmp_ge_u32 s92, 7
    s_cselect_b32 s84, s68, s80
    s_add_u32 s84, s84, 3072
    v_mfma_f32_16x16x32_bf16 v[40:43], v[116:119], a[8:11], 0
    buffer_load_dwordx4 v[112:115], v3, s[60:63], s84 offen
    v_mfma_f32_16x16x32_bf16 v[44:47], v[116:119], a[16:19], 0
    v_mfma_f32_16x16x32_bf16 v[48:51], v[116:119], a[24:27], 0
    v_mfma_f32_16x16x32_bf16 v[52:55], v[116:119], a[32:35], 0
    v_mfma_f32_16x16x32_bf16 v[56:59], v[120:123], a[0:3], 0
    s_cmp_ge_u32 s92, 7
    s_cselect_b32 s84, s69, s81
    s_add_u32 s84, s84, 3072
    v_mfma_f32_16x16x32_bf16 v[60:63], v[120:123], a[8:11], 0
    buffer_load_dwordx4 v[116:119], v3, s[60:63], s84 offen
    v_mfma_f32_16x16x32_bf16 v[64:67], v[120:123], a[16:19], 0
    v_mfma_f32_16x16x32_bf16 v[68:71], v[120:123], a[24:27], 0
    v_mfma_f32_16x16x32_bf16 v[72:75], v[120:123], a[32:35], 0
    v_mfma_f32_16x16x32_bf16 v[76:79], v[124:127], a[0:3], 0
    s_cmp_ge_u32 s92, 7
    s_cselect_b32 s84, s70, s82
    s_add_u32 s84, s84, 3072
    v_mfma_f32_16x16x32_bf16 v[80:83], v[124:127], a[8:11], 0
    buffer_load_dwordx4 v[120:123], v3, s[60:63], s84 offen
    v_mfma_f32_16x16x32_bf16 v[84:87], v[124:127], a[16:19], 0
    v_mfma_f32_16x16x32_bf16 v[88:91], v[124:127], a[24:27], 0
    v_mfma_f32_16x16x32_bf16 v[92:95], v[124:127], a[32:35], 0
    s_cmp_ge_u32 s92, 7
    s_cselect_b32 s84, s71, s83
    s_add_u32 s84, s84, 3072
    buffer_load_dwordx4 v[124:127], v3, s[60:63], s84 offen
    s_waitcnt vmcnt(8) lgkmcnt(0)
    v_mfma_f32_16x16x32_bf16 v[16:19], v[128:131], a[4:7], v[16:19]
    v_mfma_f32_16x16x32_bf16 v[20:23], v[128:131], a[12:15], v[20:23]
    v_mfma_f32_16x16x32_bf16 v[24:27], v[128:131], a[20:23], v[24:27]
    v_mfma_f32_16x16x32_bf16 v[28:31], v[128:131], a[28:31], v[28:31]
    v_mfma_f32_16x16x32_bf16 v[32:35], v[128:131], a[36:39], v[32:35]
    v_mfma_f32_16x16x32_bf16 v[36:39], v[132:135], a[4:7], v[36:39]
    s_cmp_ge_u32 s92, 6
    s_cselect_b32 s84, s68, s80
    s_add_u32 s84, s84, 4096
    v_mfma_f32_16x16x32_bf16 v[40:43], v[132:135], a[12:15], v[40:43]
    buffer_load_dwordx4 v[128:131], v3, s[60:63], s84 offen
    v_mfma_f32_16x16x32_bf16 v[44:47], v[132:135], a[20:23], v[44:47]
    v_mfma_f32_16x16x32_bf16 v[48:51], v[132:135], a[28:31], v[48:51]
    v_mfma_f32_16x16x32_bf16 v[52:55], v[132:135], a[36:39], v[52:55]
    v_mfma_f32_16x16x32_bf16 v[56:59], v[136:139], a[4:7], v[56:59]
    s_cmp_ge_u32 s92, 6
    s_cselect_b32 s84, s69, s81
    s_add_u32 s84, s84, 4096
    v_mfma_f32_16x16x32_bf16 v[60:63], v[136:139], a[12:15], v[60:63]
    buffer_load_dwordx4 v[132:135], v3, s[60:63], s84 offen
    v_mfma_f32_16x16x32_bf16 v[64:67], v[136:139], a[20:23], v[64:67]
    v_mfma_f32_16x16x32_bf16 v[68:71], v[136:139], a[28:31], v[68:71]
    v_mfma_f32_16x16x32_bf16 v[72:75], v[136:139], a[36:39], v[72:75]
    v_mfma_f32_16x16x32_bf16 v[76:79], v[140:143], a[4:7], v[76:79]
    s_cmp_ge_u32 s92, 6
    s_cselect_b32 s84, s70, s82
    s_add_u32 s84, s84, 4096
    v_mfma_f32_16x16x32_bf16 v[80:83], v[140:143], a[12:15], v[80:83]
    buffer_load_dwordx4 v[136:139], v3, s[60:63], s84 offen
    v_mfma_f32_16x16x32_bf16 v[84:87], v[140:143], a[20:23], v[84:87]
    v_mfma_f32_16x16x32_bf16 v[88:91], v[140:143], a[28:31], v[88:91]
    v_mfma_f32_16x16x32_bf16 v[92:95], v[140:143], a[36:39], v[92:95]
    s_cmp_ge_u32 s92, 6
    s_cselect_b32 s84, s71, s83
    s_add_u32 s84, s84, 4096
    buffer_load_dwordx4 v[140:143], v3, s[60:63], s84 offen
    s_waitcnt vmcnt(8) lgkmcnt(0)
    v_mfma_f32_16x16x32_bf16 v[16:19], v[144:147], a[40:43], v[16:19]
    v_mfma_f32_16x16x32_bf16 v[20:23], v[144:147], a[48:51], v[20:23]
    v_mfma_f32_16x16x32_bf16 v[24:27], v[144:147], a[56:59], v[24:27]
    v_mfma_f32_16x16x32_bf16 v[28:31], v[144:147], a[64:67], v[28:31]
    v_mfma_f32_16x16x32_bf16 v[32:35], v[144:147], a[72:75], v[32:35]
    v_mfma_f32_16x16x32_bf16 v[36:39], v[148:151], a[40:43], v[36:39]
    s_cmp_ge_u32 s92, 5
    s_cselect_b32 s84, s68, s80
    s_add_u32 s84, s84, 5120
    v_mfma_f32_16x16x32_bf16 v[40:43], v[148:151], a[48:51], v[40:43]
    buffer_load_dwordx4 v[144:147], v3, s[60:63], s84 offen
    v_mfma_f32_16x16x32_bf16 v[44:47], v[148:151], a[56:59], v[44:47]
    v_mfma_f32_16x16x32_bf16 v[48:51], v[148:151], a[64:67], v[48:51]
    v_mfma_f32_16x16x32_bf16 v[52:55], v[148:151], a[72:75], v[52:55]
    v_mfma_f32_16x16x32_bf16 v[56:59], v[152:155], a[40:43], v[56:59]
    s_cmp_ge_u32 s92, 5
    s_cselect_b32 s84, s69, s81
    s_add_u32 s84, s84, 5120
    v_mfma_f32_16x16x32_bf16 v[60:63], v[152:155], a[48:51], v[60:63]
    buffer_load_dwordx4 v[148:151], v3, s[60:63], s84 offen
    v_mfma_f32_16x16x32_bf16 v[64:67], v[152:155], a[56:59], v[64:67]
    v_mfma_f32_16x16x32_bf16 v[68:71], v[152:155], a[64:67], v[68:71]
    v_mfma_f32_16x16x32_bf16 v[72:75], v[152:155], a[72:75], v[72:75]
    v_mfma_f32_16x16x32_bf16 v[76:79], v[156:159], a[40:43], v[76:79]
    s_cmp_ge_u32 s92, 5
    s_cselect_b32 s84, s70, s82
    s_add_u32 s84, s84, 5120
    v_mfma_f32_16x16x32_bf16 v[80:83], v[156:159], a[48:51], v[80:83]
    buffer_load_dwordx4 v[152:155], v3, s[60:63], s84 offen
    v_mfma_f32_16x16x32_bf16 v[84:87], v[156:159], a[56:59], v[84:87]
    v_mfma_f32_16x16x32_bf16 v[88:91], v[156:159], a[64:67], v[88:91]
    v_mfma_f32_16x16x32_bf16 v[92:95], v[156:159], a[72:75], v[92:95]
    s_cmp_ge_u32 s92, 5
    s_cselect_b32 s84, s71, s83
    s_add_u32 s84, s84, 5120
    buffer_load_dwordx4 v[156:159], v3, s[60:63], s84 offen
    s_waitcnt vmcnt(8) lgkmcnt(0)
    v_mfma_f32_16x16x32_bf16 v[16:19], v[112:115], a[44:47], v[16:19]
    ds_read_b128 a[16:19], v1 offset:0
    v_mfma_f32_16x16x32_bf16 v[20:23], v[112:115], a[52:55], v[20:23]
    v_mfma_f32_16x16x32_bf16 v[24:27], v[112:115], a[60:63], v[24:27]
    v_mfma_f32_16x16x32_bf16 v[28:31], v[112:115], a[68:71], v[28:31]
    v_mfma_f32_16x16x32_bf16 v[32:35], v[112:115], a[76:79], v[32:35]
    v_mfma_f32_16x16x32_bf16 v[36:39], v[116:119], a[44:47], v[36:39]
    s_cmp_ge_u32 s92, 4
    s_cselect_b32 s84, s68, s80
    s_add_u32 s84, s84, 6144
    v_mfma_f32_16x16x32_bf16 v[40:43], v[116:119], a[52:55], v[40:43]
    buffer_load_dwordx4 v[112:115], v3, s[60:63], s84 offen
    v_mfma_f32_16x16x32_bf16 v[44:47], v[116:119], a[60:63], v[44:47]
    v_mfma_f32_16x16x32_bf16 v[48:51], v[116:119], a[68:71], v[48:51]
    v_mfma_f32_16x16x32_bf16 v[52:55], v[116:119], a[76:79], v[52:55]
    v_mfma_f32_16x16x32_bf16 v[56:59], v[120:123], a[44:47], v[56:59]
    s_cmp_ge_u32 s92, 4
    s_cselect_b32 s84, s69, s81
    s_add_u32 s84, s84, 6144
    v_mfma_f32_16x16x32_bf16 v[60:63], v[120:123], a[52:55], v[60:63]
    buffer_load_dwordx4 v[116:119], v3, s[60:63], s84 offen
    v_mfma_f32_16x16x32_bf16 v[64:67], v[120:123], a[60:63], v[64:67]
    v_mfma_f32_16x16x32_bf16 v[68:71], v[120:123], a[68:71], v[68:71]
    v_mfma_f32_16x16x32_bf16 v[72:75], v[120:123], a[76:79], v[72:75]
    v_mfma_f32_16x16x32_bf16 v[76:79], v[124:127], a[44:47], v[76:79]
    s_cmp_ge_u32 s92, 4
    s_cselect_b32 s84, s70, s82
    s_add_u32 s84, s84, 6144
    v_mfma_f32_16x16x32_bf16 v[80:83], v[124:127], a[52:55], v[80:83]
    buffer_load_dwordx4 v[120:123], v3, s[60:63], s84 offen
    v_mfma_f32_16x16x32_bf16 v[84:87], v[124:127], a[60:63], v[84:87]
    v_mfma_f32_16x16x32_bf16 v[88:91], v[124:127], a[68:71], v[88:91]
    v_mfma_f32_16x16x32_bf16 v[92:95], v[124:127], a[76:79], v[92:95]
    s_cmp_ge_u32 s92, 4
    s_cselect_b32 s84, s71, s83
    s_add_u32 s84, s84, 6144
    buffer_load_dwordx4 v[124:127], v3, s[60:63], s84 offen
    s_waitcnt vmcnt(8) lgkmcnt(0)
    v_mfma_f32_16x16x32_bf16 v[16:19], v[128:131], a[80:83], v[16:19]
    ds_read_b128 a[36:39], v2 offset:0
    v_mfma_f32_16x16x32_bf16 v[20:23], v[128:131], a[88:91], v[20:23]
    v_mfma_f32_16x16x32_bf16 v[24:27], v[128:131], v[96:99], v[24:27]
    v_mfma_f32_16x16x32_bf16 v[28:31], v[128:131], v[104:107], v[28:31]
    v_mfma_f32_16x16x32_bf16 v[32:35], v[128:131], a[16:19], v[32:35]
    v_mfma_f32_16x16x32_bf16 v[36:39], v[132:135], a[80:83], v[36:39]
    s_cmp_ge_u32 s92, 3
    s_cselect_b32 s84, s68, s80
    s_add_u32 s84, s84, 7168
    v_mfma_f32_16x16x32_bf16 v[40:43], v[132:135], a[88:91], v[40:43]
    buffer_load_dwordx4 v[128:131], v3, s[60:63], s84 offen
    v_mfma_f32_16x16x32_bf16 v[44:47], v[132:135], v[96:99], v[44:47]
    v_mfma_f32_16x16x32_bf16 v[48:51], v[132:135], v[104:107], v[48:51]
    v_mfma_f32_16x16x32_bf16 v[52:55], v[132:135], a[16:19], v[52:55]
    v_mfma_f32_16x16x32_bf16 v[56:59], v[136:139], a[80:83], v[56:59]
    s_cmp_ge_u32 s92, 3
    s_cselect_b32 s84, s69, s81
    s_add_u32 s84, s84, 7168
    v_mfma_f32_16x16x32_bf16 v[60:63], v[136:139], a[88:91], v[60:63]
    buffer_load_dwordx4 v[132:135], v3, s[60:63], s84 offen
    v_mfma_f32_16x16x32_bf16 v[64:67], v[136:139], v[96:99], v[64:67]
    v_mfma_f32_16x16x32_bf16 v[68:71], v[136:139], v[104:107], v[68:71]
    v_mfma_f32_16x16x32_bf16 v[72:75], v[136:139], a[16:19], v[72:75]
    v_mfma_f32_16x16x32_bf16 v[76:79], v[140:143], a[80:83], v[76:79]
    s_cmp_ge_u32 s92, 3
    s_cselect_b32 s84, s70, s82
    s_add_u32 s84, s84, 7168
    v_mfma_f32_16x16x32_bf16 v[80:83], v[140:143], a[88:91], v[80:83]
    buffer_load_dwordx4 v[136:139], v3, s[60:63], s84 offen
    v_mfma_f32_16x16x32_bf16 v[84:87], v[140:143], v[96:99], v[84:87]
    v_mfma_f32_16x16x32_bf16 v[88:91], v[140:143], v[104:107], v[88:91]
    v_mfma_f32_16x16x32_bf16 v[92:95], v[140:143], a[16:19], v[92:95]
    s_cmp_ge_u32 s92, 3
    s_cselect_b32 s84, s71, s83
    s_add_u32 s84, s84, 7168
    buffer_load_dwordx4 v[140:143], v3, s[60:63], s84 offen
    s_waitcnt vmcnt(8) lgkmcnt(0)
    v_mfma_f32_16x16x32_bf16 v[16:19], v[144:147], a[84:87], v[16:19]
    ds_read_b128 a[0:3], v1 offset:2048
    v_mfma_f32_16x16x32_bf16 v[20:23], v[144:147], a[92:95], v[20:23]
    ds_read_b128 a[4:7], v1 offset:4096
    v_mfma_f32_16x16x32_bf16 v[24:27], v[144:147], v[100:103], v[24:27]
    ds_read_b128 a[8:11], v1 offset:6144
    v_mfma_f32_16x16x32_bf16 v[28:31], v[144:147], v[108:111], v[28:31]
    ds_read_b128 a[12:15], v1 offset:8192
    v_mfma_f32_16x16x32_bf16 v[32:35], v[144:147], a[36:39], v[32:35]
    ds_read_b128 a[16:19], v1 offset:10240
    v_mfma_f32_16x16x32_bf16 v[36:39], v[148:151], a[84:87], v[36:39]
    s_cmp_ge_u32 s92, 2
    s_cselect_b32 s84, s68, s80
    s_add_u32 s84, s84, 8192
    v_mfma_f32_16x16x32_bf16 v[40:43], v[148:151], a[92:95], v[40:43]
    buffer_load_dwordx4 v[144:147], v3, s[60:63], s84 offen
    v_mfma_f32_16x16x32_bf16 v[44:47], v[148:151], v[100:103], v[44:47]
    v_mfma_f32_16x16x32_bf16 v[48:51], v[148:151], v[108:111], v[48:51]
    v_mfma_f32_16x16x32_bf16 v[52:55], v[148:151], a[36:39], v[52:55]
    v_mfma_f32_16x16x32_bf16 v[56:59], v[152:155], a[84:87], v[56:59]
    s_cmp_ge_u32 s92, 2
    s_cselect_b32 s84, s69, s81
    s_add_u32 s84, s84, 8192
    v_mfma_f32_16x16x32_bf16 v[60:63], v[152:155], a[92:95], v[60:63]
    buffer_load_dwordx4 v[148:151], v3, s[60:63], s84 offen
    v_mfma_f32_16x16x32_bf16 v[64:67], v[152:155], v[100:103], v[64:67]
    v_mfma_f32_16x16x32_bf16 v[68:71], v[152:155], v[108:111], v[68:71]
    v_mfma_f32_16x16x32_bf16 v[72:75], v[152:155], a[36:39], v[72:75]
    v_mfma_f32_16x16x32_bf16 v[76:79], v[156:159], a[84:87], v[76:79]
    s_cmp_ge_u32 s92, 2
    s_cselect_b32 s84, s70, s82
    s_add_u32 s84, s84, 8192
    v_mfma_f32_16x16x32_bf16 v[80:83], v[156:159], a[92:95], v[80:83]
    buffer_load_dwordx4 v[152:155], v3, s[60:63], s84 offen
    v_mfma_f32_16x16x32_bf16 v[84:87], v[156:159], v[100:103], v[84:87]
    v_mfma_f32_16x16x32_bf16 v[88:91], v[156:159], v[108:111], v[88:91]
    v_mfma_f32_16x16x32_bf16 v[92:95], v[156:159], a[36:39], v[92:95]
    s_cmp_ge_u32 s92, 2
    s_cselect_b32 s84, s71, s83
    s_add_u32 s84, s84, 8192
    buffer_load_dwordx4 v[156:159], v3, s[60:63], s84 offen
    s_waitcnt vmcnt(8) lgkmcnt(0)
    v_mfma_f32_16x16x32_bf16 v[16:19], v[112:115], a[0:3], v[16:19]
    ds_read_b128 a[20:23], v2 offset:2048
    v_mfma_f32_16x16x32_bf16 v[20:23], v[112:115], a[4:7], v[20:23]
    ds_read_b128 a[24:27], v2 offset:4096
    v_mfma_f32_16x16x32_bf16 v[24:27], v[112:115], a[8:11], v[24:27]
    ds_read_b128 a[28:31], v2 offset:6144
    v_mfma_f32_16x16x32_bf16 v[28:31], v[112:115], a[12:15], v[28:31]
    ds_read_b128 a[32:35], v2 offset:8192
    v_mfma_f32_16x16x32_bf16 v[32:35], v[112:115], a[16:19], v[32:35]
    ds_read_b128 a[36:39], v2 offset:10240
    v_mfma_f32_16x16x32_bf16 v[36:39], v[116:119], a[0:3], v[36:39]
    s_cmp_ge_u32 s92, 1
    s_cselect_b32 s84, s68, s80
    s_add_u32 s84, s84, 9216
    v_mfma_f32_16x16x32_bf16 v[40:43], v[116:119], a[4:7], v[40:43]
    buffer_load_dwordx4 v[112:115], v3, s[60:63], s84 offen
    v_mfma_f32_16x16x32_bf16 v[44:47], v[116:119], a[8:11], v[44:47]
    v_mfma_f32_16x16x32_bf16 v[48:51], v[116:119], a[12:15], v[48:51]
    v_mfma_f32_16x16x32_bf16 v[52:55], v[116:119], a[16:19], v[52:55]
    v_mfma_f32_16x16x32_bf16 v[56:59], v[120:123], a[0:3], v[56:59]
    s_cmp_ge_u32 s92, 1
    s_cselect_b32 s84, s69, s81
    s_add_u32 s84, s84, 9216
    v_mfma_f32_16x16x32_bf16 v[60:63], v[120:123], a[4:7], v[60:63]
    buffer_load_dwordx4 v[116:119], v3, s[60:63], s84 offen
    v_mfma_f32_16x16x32_bf16 v[64:67], v[120:123], a[8:11], v[64:67]
    v_mfma_f32_16x16x32_bf16 v[68:71], v[120:123], a[12:15], v[68:71]
    v_mfma_f32_16x16x32_bf16 v[72:75], v[120:123], a[16:19], v[72:75]
    v_mfma_f32_16x16x32_bf16 v[76:79], v[124:127], a[0:3], v[76:79]
    s_cmp_ge_u32 s92, 1
    s_cselect_b32 s84, s70, s82
    s_add_u32 s84, s84, 9216
    v_mfma_f32_16x16x32_bf16 v[80:83], v[124:127], a[4:7], v[80:83]
    buffer_load_dwordx4 v[120:123], v3, s[60:63], s84 offen
    v_mfma_f32_16x16x32_bf16 v[84:87], v[124:127], a[8:11], v[84:87]
    v_mfma_f32_16x16x32_bf16 v[88:91], v[124:127], a[12:15], v[88:91]
    v_mfma_f32_16x16x32_bf16 v[92:95], v[124:127], a[16:19], v[92:95]
    s_cmp_ge_u32 s92, 1
    s_cselect_b32 s84, s71, s83
    s_add_u32 s84, s84, 9216
    buffer_load_dwordx4 v[124:127], v3, s[60:63], s84 offen
    s_waitcnt vmcnt(8) lgkmcnt(0)
    v_mfma_f32_16x16x32_bf16 v[16:19], v[128:131], a[20:23], v[16:19]
    ds_read_b128 a[0:3], v1 offset:12288
    v_mfma_f32_16x16x32_bf16 v[20:23], v[128:131], a[24:27], v[20:23]
    ds_read_b128 a[4:7], v1 offset:14336
    v_mfma_f32_16x16x32_bf16 v[24:27], v[128:131], a[28:31], v[24:27]
    ds_read_b128 a[8:11], v1 offset:16384
    v_mfma_f32_16x16x32_bf16 v[28:31], v[128:131], a[32:35], v[28:31]
    ds_read_b128 a[12:15], v1 offset:18432
    v_mfma_f32_16x16x32_bf16 v[32:35], v[128:131], a[36:39], v[32:35]
    ds_read_b128 a[16:19], v1 offset:20480
    v_mfma_f32_16x16x32_bf16 v[36:39], v[132:135], a[20:23], v[36:39]
    v_mfma_f32_16x16x32_bf16 v[40:43], v[132:135], a[24:27], v[40:43]
    v_mfma_f32_16x16x32_bf16 v[44:47], v[132:135], a[28:31], v[44:47]
    v_mfma_f32_16x16x32_bf16 v[48:51], v[132:135], a[32:35], v[48:51]
    v_mfma_f32_16x16x32_bf16 v[52:55], v[132:135], a[36:39], v[52:55]
    v_mfma_f32_16x16x32_bf16 v[56:59], v[136:139], a[20:23], v[56:59]
    v_mfma_f32_16x16x32_bf16 v[60:63], v[136:139], a[24:27], v[60:63]
    v_mfma_f32_16x16x32_bf16 v[64:67], v[136:139], a[28:31], v[64:67]
    v_mfma_f32_16x16x32_bf16 v[68:71], v[136:139], a[32:35], v[68:71]
    v_mfma_f32_16x16x32_bf16 v[72:75], v[136:139], a[36:39], v[72:75]
    v_mfma_f32_16x16x32_bf16 v[76:79], v[140:143], a[20:23], v[76:79]
    v_mfma_f32_16x16x32_bf16 v[80:83], v[140:143], a[24:27], v[80:83]
    v_mfma_f32_16x16x32_bf16 v[84:87], v[140:143], a[28:31], v[84:87]
    v_mfma_f32_16x16x32_bf16 v[88:91], v[140:143], a[32:35], v[88:91]
    v_mfma_f32_16x16x32_bf16 v[92:95], v[140:143], a[36:39], v[92:95]
    s_waitcnt vmcnt(4) lgkmcnt(0)
    v_mfma_f32_16x16x32_bf16 v[16:19], v[144:147], a[0:3], v[16:19]
    ds_read_b128 a[20:23], v2 offset:12288
    v_mfma_f32_16x16x32_bf16 v[20:23], v[144:147], a[4:7], v[20:23]
    ds_read_b128 a[24:27], v2 offset:14336
    v_mfma_f32_16x16x32_bf16 v[24:27], v[144:147], a[8:11], v[24:27]
    ds_read_b128 a[28:31], v2 offset:16384
    v_mfma_f32_16x16x32_bf16 v[28:31], v[144:147], a[12:15], v[28:31]
    ds_read_b128 a[32:35], v2 offset:18432
    v_mfma_f32_16x16x32_bf16 v[32:35], v[144:147], a[16:19], v[32:35]
    ds_read_b128 a[36:39], v2 offset:20480
    v_mfma_f32_16x16x32_bf16 v[36:39], v[148:151], a[0:3], v[36:39]
    v_mfma_f32_16x16x32_bf16 v[40:43], v[148:151], a[4:7], v[40:43]
    v_mfma_f32_16x16x32_bf16 v[44:47], v[148:151], a[8:11], v[44:47]
    v_mfma_f32_16x16x32_bf16 v[48:51], v[148:151], a[12:15], v[48:51]
    v_mfma_f32_16x16x32_bf16 v[52:55], v[148:151], a[16:19], v[52:55]
    v_mfma_f32_16x16x32_bf16 v[56:59], v[152:155], a[0:3], v[56:59]
    v_mfma_f32_16x16x32_bf16 v[60:63], v[152:155], a[4:7], v[60:63]
    v_mfma_f32_16x16x32_bf16 v[64:67], v[152:155], a[8:11], v[64:67]
    v_mfma_f32_16x16x32_bf16 v[68:71], v[152:155], a[12:15], v[68:71]
    v_mfma_f32_16x16x32_bf16 v[72:75], v[152:155], a[16:19], v[72:75]
    v_mfma_f32_16x16x32_bf16 v[76:79], v[156:159], a[0:3], v[76:79]
    v_mfma_f32_16x16x32_bf16 v[80:83], v[156:159], a[4:7], v[80:83]
    v_mfma_f32_16x16x32_bf16 v[84:87], v[156:159], a[8:11], v[84:87]
    v_mfma_f32_16x16x32_bf16 v[88:91], v[156:159], a[12:15], v[88:91]
    v_mfma_f32_16x16x32_bf16 v[92:95], v[156:159], a[16:19], v[92:95]
    s_waitcnt vmcnt(0) lgkmcnt(0)
    v_mfma_f32_16x16x32_bf16 v[16:19], v[112:115], a[20:23], v[16:19]
    v_mfma_f32_16x16x32_bf16 v[20:23], v[112:115], a[24:27], v[20:23]
    v_mfma_f32_16x16x32_bf16 v[24:27], v[112:115], a[28:31], v[24:27]
    v_mfma_f32_16x16x32_bf16 v[28:31], v[112:115], a[32:35], v[28:31]
    v_mfma_f32_16x16x32_bf16 v[32:35], v[112:115], a[36:39], v[32:35]
    v_mfma_f32_16x16x32_bf16 v[36:39], v[116:119], a[20:23], v[36:39]
    v_mfma_f32_16x16x32_bf16 v[40:43], v[116:119], a[24:27], v[40:43]
    v_mfma_f32_16x16x32_bf16 v[44:47], v[116:119], a[28:31], v[44:47]
    v_mfma_f32_16x16x32_bf16 v[48:51], v[116:119], a[32:35], v[48:51]
    v_mfma_f32_16x16x32_bf16 v[52:55], v[116:119], a[36:39], v[52:55]
    v_mfma_f32_16x16x32_bf16 v[56:59], v[120:123], a[20:23], v[56:59]
    v_mfma_f32_16x16x32_bf16 v[60:63], v[120:123], a[24:27], v[60:63]
    v_mfma_f32_16x16x32_bf16 v[64:67], v[120:123], a[28:31], v[64:67]
    v_mfma_f32_16x16x32_bf16 v[68:71], v[120:123], a[32:35], v[68:71]
    v_mfma_f32_16x16x32_bf16 v[72:75], v[120:123], a[36:39], v[72:75]
    v_mfma_f32_16x16x32_bf16 v[76:79], v[124:127], a[20:23], v[76:79]
    v_mfma_f32_16x16x32_bf16 v[80:83], v[124:127], a[24:27], v[80:83]
    v_mfma_f32_16x16x32_bf16 v[84:87], v[124:127], a[28:31], v[84:87]
    v_mfma_f32_16x16x32_bf16 v[88:91], v[124:127], a[32:35], v[88:91]
    v_mfma_f32_16x16x32_bf16 v[92:95], v[124:127], a[36:39], v[92:95]
L_g2join_77:
    s_nop 7
    s_nop 1
    v_lshlrev_b32 v3, 4, v0
    v_add_u32 v4, s93, v3
    s_cmp_eq_u32 s3, 0
    s_cbranch_scc1 L_pw_78
    ds_write_b128 v4, v[16:19] offset:0
    ds_write_b128 v4, v[20:23] offset:1024
    ds_write_b128 v4, v[24:27] offset:2048
    ds_write_b128 v4, v[28:31] offset:3072
    ds_write_b128 v4, v[32:35] offset:4096
L_pw_78:
    s_cmp_eq_u32 s3, 1
    s_cbranch_scc1 L_pw_79
    ds_write_b128 v4, v[36:39] offset:5120
    ds_write_b128 v4, v[40:43] offset:6144
    ds_write_b128 v4, v[44:47] offset:7168
    ds_write_b128 v4, v[48:51] offset:8192
    ds_write_b128 v4, v[52:55] offset:9216
L_pw_79:
    s_cmp_eq_u32 s3, 2
    s_cbranch_scc1 L_pw_80
    ds_write_b128 v4, v[56:59] offset:10240
    ds_write_b128 v4, v[60:63] offset:11264
    ds_write_b128 v4, v[64:67] offset:12288
    ds_write_b128 v4, v[68:71] offset:13312
    ds_write_b128 v4, v[72:75] offset:14336
L_pw_80:
    s_cmp_eq_u32 s3, 3
    s_cbranch_scc1 L_pw_81
    ds_write_b128 v4, v[76:79] offset:15360
    ds_write_b128 v4, v[80:83] offset:16384
    ds_write_b128 v4, v[84:87] offset:17408
    ds_write_b128 v4, v[88:91] offset:18432
    ds_write_b128 v4, v[92:95] offset:19456
L_pw_81:
    s_cmp_lg_u32 s3, 0
    s_cbranch_scc1 L_po_82
    v_mov_b32 v96, v16
    v_mov_b32 v97, v17
    v_mov_b32 v98, v18
    v_mov_b32 v99, v19
    v_mov_b32 v100, v20
    v_mov_b32 v101, v21
    v_mov_b32 v102, v22
    v_mov_b32 v103, v23
    v_mov_b32 v104, v24
    v_mov_b32 v105, v25
    v_mov_b32 v106, v26
    v_mov_b32 v107, v27
    v_mov_b32 v108, v28
    v_mov_b32 v109, v29
    v_mov_b32 v110, v30
    v_mov_b32 v111, v31
    v_mov_b32 v112, v32
    v_mov_b32 v113, v33
    v_mov_b32 v114, v34
    v_mov_b32 v115, v35
L_po_82:
    s_cmp_lg_u32 s3, 1
    s_cbranch_scc1 L_po_83
    v_mov_b32 v96, v36
    v_mov_b32 v97, v37
    v_mov_b32 v98, v38
    v_mov_b32 v99, v39
    v_mov_b32 v100, v40
    v_mov_b32 v101, v41
    v_mov_b32 v102, v42
    v_mov_b32 v103, v43
    v_mov_b32 v104, v44
    v_mov_b32 v105, v45
    v_mov_b32 v106, v46
    v_mov_b32 v107, v47
    v_mov_b32 v108, v48
    v_mov_b32 v109, v49
    v_mov_b32 v110, v50
    v_mov_b32 v111, v51
    v_mov_b32 v112, v52
    v_mov_b32 v113, v53
    v_mov_b32 v114, v54
    v_mov_b32 v115, v55
L_po_83:
    s_cmp_lg_u32 s3, 2
    s_cbranch_scc1 L_po_84
    v_mov_b32 v96, v56
    v_mov_b32 v97, v57
    v_mov_b32 v98, v58
    v_mov_b32 v99, v59
    v_mov_b32 v100, v60
    v_mov_b32 v101, v61
    v_mov_b32 v102, v62
    v_mov_b32 v103, v63
    v_mov_b32 v104, v64
    v_mov_b32 v105, v65
    v_mov_b32 v106, v66
    v_mov_b32 v107, v67
    v_mov_b32 v108, v68
    v_mov_b32 v109, v69
    v_mov_b32 v110, v70
    v_mov_b32 v111, v71
    v_mov_b32 v112, v72
    v_mov_b32 v113, v73
    v_mov_b32 v114, v74
    v_mov_b32 v115, v75
L_po_84:
    s_cmp_lg_u32 s3, 3
    s_cbranch_scc1 L_po_85
    v_mov_b32 v96, v76
    v_mov_b32 v97, v77
    v_mov_b32 v98, v78
    v_mov_b32 v99, v79
    v_mov_b32 v100, v80
    v_mov_b32 v101, v81
    v_mov_b32 v102, v82
    v_mov_b32 v103, v83
    v_mov_b32 v104, v84
    v_mov_b32 v105, v85
    v_mov_b32 v106, v86
    v_mov_b32 v107, v87
    v_mov_b32 v108, v88
    v_mov_b32 v109, v89
    v_mov_b32 v110, v90
    v_mov_b32 v111, v91
    v_mov_b32 v112, v92
    v_mov_b32 v113, v93
    v_mov_b32 v114, v94
    v_mov_b32 v115, v95
L_po_85:
    v_and_b32 v8, 15, v0
    v_lshrrev_b32 v9, 4, v0
    v_mul_u32_u24 v10, 144, v8
    v_lshlrev_b32 v11, 3, v9
    v_add_u32 v10, v10, v11
    s_lshl_b32 s9, s3, 5
    v_add_u32 v10, s9, v10
    v_add_u32 v10, 151552, v10
    s_lshl_b32 s10, s6, 7
    s_add_u32 s10, s10, s9
    s_add_u32 s10, s10, 0
    v_add_u32 v11, s10, v11
    v_mul_u32_u24 v140, 10240, v9
    v_lshlrev_b32 v13, 2, v8
    v_add_u32 v136, v140, v13
    v_add_u32 v137, 2560, v136
    v_add_u32 v138, 5120, v136
    v_add_u32 v139, 7680, v136
    s_lshl_b32 s86, s6, 2
    s_add_u32 s86, s86, s3
    s_mul_i32 s86, s86, 40960
    s_mul_i32 s10, s7, 320
    s_add_u32 s86, s86, s10
    s_add_u32 s9, s3, 1
    s_and_b32 s9, s9, 3
    s_mul_i32 s9, s9, 24576
    s_mul_i32 s10, s3, 5120
    s_add_u32 s9, s9, s10
    s_add_u32 s9, s9, 4096
    v_add_u32 v5, s9, v3
    s_add_u32 s9, s3, 2
    s_and_b32 s9, s9, 3
    s_mul_i32 s9, s9, 24576
    s_mul_i32 s10, s3, 5120
    s_add_u32 s9, s9, s10
    s_add_u32 s9, s9, 4096
    v_add_u32 v6, s9, v3
    s_add_u32 s9, s3, 3
    s_and_b32 s9, s9, 3
    s_mul_i32 s9, s9, 24576
    s_mul_i32 s10, s3, 5120
    s_add_u32 s9, s9, s10
    s_add_u32 s9, s9, 4096
    v_add_u32 v7, s9, v3
    s_waitcnt lgkmcnt(0)
    v_mov_b32 v13, 15
    s_mov_b64 exec, 1
    ds_write_b32 v14, v13
    s_mov_b64 exec, -1
    s_mov_b32 s14, 640000
L_s5w_86:
    ds_read_b32 v13, v15
    s_waitcnt lgkmcnt(0)
    v_cmp_gt_u32 vcc, 15, v13
    s_cbranch_vccz L_s5wd_87
    s_sub_u32 s14, s14, 1
    s_cmp_lg_u32 s14, 0
    s_cbranch_scc1 L_s5w_86
L_s5wd_87:
    ds_read_b128 v[16:19], v5 offset:0
    ds_read_b128 v[20:23], v5 offset:1024
    ds_read_b128 v[24:27], v5 offset:2048
    ds_read_b128 v[28:31], v5 offset:3072
    ds_read_b128 v[32:35], v5 offset:4096
    ds_read_b128 v[36:39], v6 offset:0
    ds_read_b128 v[40:43], v6 offset:1024
    ds_read_b128 v[44:47], v6 offset:2048
    ds_read_b128 v[48:51], v6 offset:3072
    ds_read_b128 v[52:55], v6 offset:4096
    ds_read_b128 v[56:59], v7 offset:0
    ds_read_b128 v[60:63], v7 offset:1024
    ds_read_b128 v[64:67], v7 offset:2048
    ds_read_b128 v[68:71], v7 offset:3072
    ds_read_b128 v[72:75], v7 offset:4096
    v_mov_b32 v8, 163076
    s_mov_b32 s14, 640000
L_wr_88:
    ds_read_b32 v9, v8
    s_waitcnt lgkmcnt(0)
    v_cmp_gt_u32 vcc, 1, v9
    s_cbranch_vccz L_wrd_89
    s_sleep 1
    s_sub_u32 s14, s14, 1
    s_cmp_lg_u32 s14, 0
    s_cbranch_scc1 L_wr_88
L_wrd_89:
    ds_read_b64 v[120:121], v10 offset:0
    ds_read_b64 v[122:123], v10 offset:2304
    ds_read_b64 v[124:125], v10 offset:4608
    ds_read_b64 v[126:127], v10 offset:6912
    ds_read_b64 v[128:129], v10 offset:9216
    ds_read_b64 v[130:131], v11
    v_pk_add_f32 v[96:97], v[96:97], v[16:17]
    v_pk_add_f32 v[98:99], v[98:99], v[18:19]
    v_pk_add_f32 v[36:37], v[36:37], v[56:57]
    v_pk_add_f32 v[38:39], v[38:39], v[58:59]
    v_pk_add_f32 v[96:97], v[96:97], v[36:37]
    v_pk_add_f32 v[98:99], v[98:99], v[38:39]
    v_pk_add_f32 v[100:101], v[100:101], v[20:21]
    v_pk_add_f32 v[102:103], v[102:103], v[22:23]
    v_pk_add_f32 v[40:41], v[40:41], v[60:61]
    v_pk_add_f32 v[42:43], v[42:43], v[62:63]
    v_pk_add_f32 v[100:101], v[100:101], v[40:41]
    v_pk_add_f32 v[102:103], v[102:103], v[42:43]
    v_pk_add_f32 v[104:105], v[104:105], v[24:25]
    v_pk_add_f32 v[106:107], v[106:107], v[26:27]
    v_pk_add_f32 v[44:45], v[44:45], v[64:65]
    v_pk_add_f32 v[46:47], v[46:47], v[66:67]
    v_pk_add_f32 v[104:105], v[104:105], v[44:45]
    v_pk_add_f32 v[106:107], v[106:107], v[46:47]
    v_pk_add_f32 v[108:109], v[108:109], v[28:29]
    v_pk_add_f32 v[110:111], v[110:111], v[30:31]
    v_pk_add_f32 v[48:49], v[48:49], v[68:69]
    v_pk_add_f32 v[50:51], v[50:51], v[70:71]
    v_pk_add_f32 v[108:109], v[108:109], v[48:49]
    v_pk_add_f32 v[110:111], v[110:111], v[50:51]
    v_pk_add_f32 v[112:113], v[112:113], v[32:33]
    v_pk_add_f32 v[114:115], v[114:115], v[34:35]
    v_pk_add_f32 v[52:53], v[52:53], v[72:73]
    v_pk_add_f32 v[54:55], v[54:55], v[74:75]
    v_pk_add_f32 v[112:113], v[112:113], v[52:53]
    v_pk_add_f32 v[114:115], v[114:115], v[54:55]
    s_waitcnt lgkmcnt(0)
    v_lshlrev_b32 v132, 16, v130
    v_and_b32 v133, 0xffff0000, v130
    v_lshlrev_b32 v134, 16, v131
    v_and_b32 v135, 0xffff0000, v131
    v_lshlrev_b32 v16, 16, v120
    v_and_b32 v17, 0xffff0000, v120
    v_lshlrev_b32 v18, 16, v121
    v_and_b32 v19, 0xffff0000, v121
    v_pk_fma_f32 v[96:97], v[132:133], v[96:97], v[16:17]
    v_pk_fma_f32 v[98:99], v[134:135], v[98:99], v[18:19]
    buffer_store_dword v96, v136, s[64:67], s86 offen offset:0 nt
    buffer_store_dword v97, v137, s[64:67], s86 offen offset:0 nt
    buffer_store_dword v98, v138, s[64:67], s86 offen offset:0 nt
    buffer_store_dword v99, v139, s[64:67], s86 offen offset:0 nt
    v_lshlrev_b32 v20, 16, v122
    v_and_b32 v21, 0xffff0000, v122
    v_lshlrev_b32 v22, 16, v123
    v_and_b32 v23, 0xffff0000, v123
    v_pk_fma_f32 v[100:101], v[132:133], v[100:101], v[20:21]
    v_pk_fma_f32 v[102:103], v[134:135], v[102:103], v[22:23]
    buffer_store_dword v100, v136, s[64:67], s86 offen offset:64 nt
    buffer_store_dword v101, v137, s[64:67], s86 offen offset:64 nt
    buffer_store_dword v102, v138, s[64:67], s86 offen offset:64 nt
    buffer_store_dword v103, v139, s[64:67], s86 offen offset:64 nt
    v_lshlrev_b32 v24, 16, v124
    v_and_b32 v25, 0xffff0000, v124
    v_lshlrev_b32 v26, 16, v125
    v_and_b32 v27, 0xffff0000, v125
    v_pk_fma_f32 v[104:105], v[132:133], v[104:105], v[24:25]
    v_pk_fma_f32 v[106:107], v[134:135], v[106:107], v[26:27]
    buffer_store_dword v104, v136, s[64:67], s86 offen offset:128 nt
    buffer_store_dword v105, v137, s[64:67], s86 offen offset:128 nt
    buffer_store_dword v106, v138, s[64:67], s86 offen offset:128 nt
    buffer_store_dword v107, v139, s[64:67], s86 offen offset:128 nt
    v_lshlrev_b32 v28, 16, v126
    v_and_b32 v29, 0xffff0000, v126
    v_lshlrev_b32 v30, 16, v127
    v_and_b32 v31, 0xffff0000, v127
    v_pk_fma_f32 v[108:109], v[132:133], v[108:109], v[28:29]
    v_pk_fma_f32 v[110:111], v[134:135], v[110:111], v[30:31]
    buffer_store_dword v108, v136, s[64:67], s86 offen offset:192 nt
    buffer_store_dword v109, v137, s[64:67], s86 offen offset:192 nt
    buffer_store_dword v110, v138, s[64:67], s86 offen offset:192 nt
    buffer_store_dword v111, v139, s[64:67], s86 offen offset:192 nt
    v_lshlrev_b32 v32, 16, v128
    v_and_b32 v33, 0xffff0000, v128
    v_lshlrev_b32 v34, 16, v129
    v_and_b32 v35, 0xffff0000, v129
    v_pk_fma_f32 v[112:113], v[132:133], v[112:113], v[32:33]
    v_pk_fma_f32 v[114:115], v[134:135], v[114:115], v[34:35]
    buffer_store_dword v112, v136, s[64:67], s86 offen offset:256 nt
    buffer_store_dword v113, v137, s[64:67], s86 offen offset:256 nt
    buffer_store_dword v114, v138, s[64:67], s86 offen offset:256 nt
    buffer_store_dword v115, v139, s[64:67], s86 offen offset:256 nt
    s_branch L_exit
L_g2slow_76:
    s_cmp_ge_u32 s92, 10
    s_cselect_b32 s84, s68, s80
    s_add_u32 s84, s84, 0
    buffer_load_dwordx4 v[112:115], v3, s[60:63], s84 offen sc1
    s_cmp_ge_u32 s92, 10
    s_cselect_b32 s84, s69, s81
    s_add_u32 s84, s84, 0
    buffer_load_dwordx4 v[116:119], v3, s[60:63], s84 offen sc1
    s_cmp_ge_u32 s92, 10
    s_cselect_b32 s84, s70, s82
    s_add_u32 s84, s84, 0
    buffer_load_dwordx4 v[120:123], v3, s[60:63], s84 offen sc1
    s_cmp_ge_u32 s92, 10
    s_cselect_b32 s84, s71, s83
    s_add_u32 s84, s84, 0
    buffer_load_dwordx4 v[124:127], v3, s[60:63], s84 offen sc1
    s_cmp_ge_u32 s92, 9
    s_cselect_b32 s84, s68, s80
    s_add_u32 s84, s84, 1024
    buffer_load_dwordx4 v[128:131], v3, s[60:63], s84 offen sc1
    s_cmp_ge_u32 s92, 9
    s_cselect_b32 s84, s69, s81
    s_add_u32 s84, s84, 1024
    buffer_load_dwordx4 v[132:135], v3, s[60:63], s84 offen sc1
    s_cmp_ge_u32 s92, 9
    s_cselect_b32 s84, s70, s82
    s_add_u32 s84, s84, 1024
    buffer_load_dwordx4 v[136:139], v3, s[60:63], s84 offen sc1
    s_cmp_ge_u32 s92, 9
    s_cselect_b32 s84, s71, s83
    s_add_u32 s84, s84, 1024
    buffer_load_dwordx4 v[140:143], v3, s[60:63], s84 offen sc1
    s_cmp_ge_u32 s92, 8
    s_cselect_b32 s84, s68, s80
    s_add_u32 s84, s84, 2048
    buffer_load_dwordx4 v[144:147], v3, s[60:63], s84 offen sc1
    s_cmp_ge_u32 s92, 8
    s_cselect_b32 s84, s69, s81
    s_add_u32 s84, s84, 2048
    buffer_load_dwordx4 v[148:151], v3, s[60:63], s84 offen sc1
    s_cmp_ge_u32 s92, 8
    s_cselect_b32 s84, s70, s82
    s_add_u32 s84, s84, 2048
    buffer_load_dwordx4 v[152:155], v3, s[60:63], s84 offen sc1
    s_cmp_ge_u32 s92, 8
    s_cselect_b32 s84, s71, s83
    s_add_u32 s84, s84, 2048
    buffer_load_dwordx4 v[156:159], v3, s[60:63], s84 offen sc1
    s_waitcnt vmcnt(8) lgkmcnt(0)
    v_mfma_f32_16x16x32_bf16 v[16:19], v[112:115], a[0:3], 0
    v_mfma_f32_16x16x32_bf16 v[20:23], v[112:115], a[8:11], 0
    v_mfma_f32_16x16x32_bf16 v[24:27], v[112:115], a[16:19], 0
    v_mfma_f32_16x16x32_bf16 v[28:31], v[112:115], a[24:27], 0
    v_mfma_f32_16x16x32_bf16 v[32:35], v[112:115], a[32:35], 0
    v_mfma_f32_16x16x32_bf16 v[36:39], v[116:119], a[0:3], 0
    s_cmp_ge_u32 s92, 7
    s_cselect_b32 s84, s68, s80
    s_add_u32 s84, s84, 3072
    v_mfma_f32_16x16x32_bf16 v[40:43], v[116:119], a[8:11], 0
    buffer_load_dwordx4 v[112:115], v3, s[60:63], s84 offen sc1
    v_mfma_f32_16x16x32_bf16 v[44:47], v[116:119], a[16:19], 0
    v_mfma_f32_16x16x32_bf16 v[48:51], v[116:119], a[24:27], 0
    v_mfma_f32_16x16x32_bf16 v[52:55], v[116:119], a[32:35], 0
    v_mfma_f32_16x16x32_bf16 v[56:59], v[120:123], a[0:3], 0
    s_cmp_ge_u32 s92, 7
    s_cselect_b32 s84, s69, s81
    s_add_u32 s84, s84, 3072
    v_mfma_f32_16x16x32_bf16 v[60:63], v[120:123], a[8:11], 0
    buffer_load_dwordx4 v[116:119], v3, s[60:63], s84 offen sc1
    v_mfma_f32_16x16x32_bf16 v[64:67], v[120:123], a[16:19], 0
    v_mfma_f32_16x16x32_bf16 v[68:71], v[120:123], a[24:27], 0
    v_mfma_f32_16x16x32_bf16 v[72:75], v[120:123], a[32:35], 0
    v_mfma_f32_16x16x32_bf16 v[76:79], v[124:127], a[0:3], 0
    s_cmp_ge_u32 s92, 7
    s_cselect_b32 s84, s70, s82
    s_add_u32 s84, s84, 3072
    v_mfma_f32_16x16x32_bf16 v[80:83], v[124:127], a[8:11], 0
    buffer_load_dwordx4 v[120:123], v3, s[60:63], s84 offen sc1
    v_mfma_f32_16x16x32_bf16 v[84:87], v[124:127], a[16:19], 0
    v_mfma_f32_16x16x32_bf16 v[88:91], v[124:127], a[24:27], 0
    v_mfma_f32_16x16x32_bf16 v[92:95], v[124:127], a[32:35], 0
    s_cmp_ge_u32 s92, 7
    s_cselect_b32 s84, s71, s83
    s_add_u32 s84, s84, 3072
    buffer_load_dwordx4 v[124:127], v3, s[60:63], s84 offen sc1
    s_waitcnt vmcnt(8) lgkmcnt(0)
    v_mfma_f32_16x16x32_bf16 v[16:19], v[128:131], a[4:7], v[16:19]
    v_mfma_f32_16x16x32_bf16 v[20:23], v[128:131], a[12:15], v[20:23]
    v_mfma_f32_16x16x32_bf16 v[24:27], v[128:131], a[20:23], v[24:27]
    v_mfma_f32_16x16x32_bf16 v[28:31], v[128:131], a[28:31], v[28:31]
    v_mfma_f32_16x16x32_bf16 v[32:35], v[128:131], a[36:39], v[32:35]
    v_mfma_f32_16x16x32_bf16 v[36:39], v[132:135], a[4:7], v[36:39]
    s_cmp_ge_u32 s92, 6
    s_cselect_b32 s84, s68, s80
    s_add_u32 s84, s84, 4096
    v_mfma_f32_16x16x32_bf16 v[40:43], v[132:135], a[12:15], v[40:43]
    buffer_load_dwordx4 v[128:131], v3, s[60:63], s84 offen sc1
    v_mfma_f32_16x16x32_bf16 v[44:47], v[132:135], a[20:23], v[44:47]
    v_mfma_f32_16x16x32_bf16 v[48:51], v[132:135], a[28:31], v[48:51]
    v_mfma_f32_16x16x32_bf16 v[52:55], v[132:135], a[36:39], v[52:55]
    v_mfma_f32_16x16x32_bf16 v[56:59], v[136:139], a[4:7], v[56:59]
    s_cmp_ge_u32 s92, 6
    s_cselect_b32 s84, s69, s81
    s_add_u32 s84, s84, 4096
    v_mfma_f32_16x16x32_bf16 v[60:63], v[136:139], a[12:15], v[60:63]
    buffer_load_dwordx4 v[132:135], v3, s[60:63], s84 offen sc1
    v_mfma_f32_16x16x32_bf16 v[64:67], v[136:139], a[20:23], v[64:67]
    v_mfma_f32_16x16x32_bf16 v[68:71], v[136:139], a[28:31], v[68:71]
    v_mfma_f32_16x16x32_bf16 v[72:75], v[136:139], a[36:39], v[72:75]
    v_mfma_f32_16x16x32_bf16 v[76:79], v[140:143], a[4:7], v[76:79]
    s_cmp_ge_u32 s92, 6
    s_cselect_b32 s84, s70, s82
    s_add_u32 s84, s84, 4096
    v_mfma_f32_16x16x32_bf16 v[80:83], v[140:143], a[12:15], v[80:83]
    buffer_load_dwordx4 v[136:139], v3, s[60:63], s84 offen sc1
    v_mfma_f32_16x16x32_bf16 v[84:87], v[140:143], a[20:23], v[84:87]
    v_mfma_f32_16x16x32_bf16 v[88:91], v[140:143], a[28:31], v[88:91]
    v_mfma_f32_16x16x32_bf16 v[92:95], v[140:143], a[36:39], v[92:95]
    s_cmp_ge_u32 s92, 6
    s_cselect_b32 s84, s71, s83
    s_add_u32 s84, s84, 4096
    buffer_load_dwordx4 v[140:143], v3, s[60:63], s84 offen sc1
    s_waitcnt vmcnt(8) lgkmcnt(0)
    v_mfma_f32_16x16x32_bf16 v[16:19], v[144:147], a[40:43], v[16:19]
    v_mfma_f32_16x16x32_bf16 v[20:23], v[144:147], a[48:51], v[20:23]
    v_mfma_f32_16x16x32_bf16 v[24:27], v[144:147], a[56:59], v[24:27]
    v_mfma_f32_16x16x32_bf16 v[28:31], v[144:147], a[64:67], v[28:31]
    v_mfma_f32_16x16x32_bf16 v[32:35], v[144:147], a[72:75], v[32:35]
    v_mfma_f32_16x16x32_bf16 v[36:39], v[148:151], a[40:43], v[36:39]
    s_cmp_ge_u32 s92, 5
    s_cselect_b32 s84, s68, s80
    s_add_u32 s84, s84, 5120
    v_mfma_f32_16x16x32_bf16 v[40:43], v[148:151], a[48:51], v[40:43]
    buffer_load_dwordx4 v[144:147], v3, s[60:63], s84 offen sc1
    v_mfma_f32_16x16x32_bf16 v[44:47], v[148:151], a[56:59], v[44:47]
    v_mfma_f32_16x16x32_bf16 v[48:51], v[148:151], a[64:67], v[48:51]
    v_mfma_f32_16x16x32_bf16 v[52:55], v[148:151], a[72:75], v[52:55]
    v_mfma_f32_16x16x32_bf16 v[56:59], v[152:155], a[40:43], v[56:59]
    s_cmp_ge_u32 s92, 5
    s_cselect_b32 s84, s69, s81
    s_add_u32 s84, s84, 5120
    v_mfma_f32_16x16x32_bf16 v[60:63], v[152:155], a[48:51], v[60:63]
    buffer_load_dwordx4 v[148:151], v3, s[60:63], s84 offen sc1
    v_mfma_f32_16x16x32_bf16 v[64:67], v[152:155], a[56:59], v[64:67]
    v_mfma_f32_16x16x32_bf16 v[68:71], v[152:155], a[64:67], v[68:71]
    v_mfma_f32_16x16x32_bf16 v[72:75], v[152:155], a[72:75], v[72:75]
    v_mfma_f32_16x16x32_bf16 v[76:79], v[156:159], a[40:43], v[76:79]
    s_cmp_ge_u32 s92, 5
    s_cselect_b32 s84, s70, s82
    s_add_u32 s84, s84, 5120
    v_mfma_f32_16x16x32_bf16 v[80:83], v[156:159], a[48:51], v[80:83]
    buffer_load_dwordx4 v[152:155], v3, s[60:63], s84 offen sc1
    v_mfma_f32_16x16x32_bf16 v[84:87], v[156:159], a[56:59], v[84:87]
    v_mfma_f32_16x16x32_bf16 v[88:91], v[156:159], a[64:67], v[88:91]
    v_mfma_f32_16x16x32_bf16 v[92:95], v[156:159], a[72:75], v[92:95]
    s_cmp_ge_u32 s92, 5
    s_cselect_b32 s84, s71, s83
    s_add_u32 s84, s84, 5120
    buffer_load_dwordx4 v[156:159], v3, s[60:63], s84 offen sc1
    s_waitcnt vmcnt(8) lgkmcnt(0)
    v_mfma_f32_16x16x32_bf16 v[16:19], v[112:115], a[44:47], v[16:19]
    ds_read_b128 a[16:19], v1 offset:0
    v_mfma_f32_16x16x32_bf16 v[20:23], v[112:115], a[52:55], v[20:23]
    v_mfma_f32_16x16x32_bf16 v[24:27], v[112:115], a[60:63], v[24:27]
    v_mfma_f32_16x16x32_bf16 v[28:31], v[112:115], a[68:71], v[28:31]
    v_mfma_f32_16x16x32_bf16 v[32:35], v[112:115], a[76:79], v[32:35]
    v_mfma_f32_16x16x32_bf16 v[36:39], v[116:119], a[44:47], v[36:39]
    s_cmp_ge_u32 s92, 4
    s_cselect_b32 s84, s68, s80
    s_add_u32 s84, s84, 6144
    v_mfma_f32_16x16x32_bf16 v[40:43], v[116:119], a[52:55], v[40:43]
    buffer_load_dwordx4 v[112:115], v3, s[60:63], s84 offen sc1
    v_mfma_f32_16x16x32_bf16 v[44:47], v[116:119], a[60:63], v[44:47]
    v_mfma_f32_16x16x32_bf16 v[48:51], v[116:119], a[68:71], v[48:51]
    v_mfma_f32_16x16x32_bf16 v[52:55], v[116:119], a[76:79], v[52:55]
    v_mfma_f32_16x16x32_bf16 v[56:59], v[120:123], a[44:47], v[56:59]
    s_cmp_ge_u32 s92, 4
    s_cselect_b32 s84, s69, s81
    s_add_u32 s84, s84, 6144
    v_mfma_f32_16x16x32_bf16 v[60:63], v[120:123], a[52:55], v[60:63]
    buffer_load_dwordx4 v[116:119], v3, s[60:63], s84 offen sc1
    v_mfma_f32_16x16x32_bf16 v[64:67], v[120:123], a[60:63], v[64:67]
    v_mfma_f32_16x16x32_bf16 v[68:71], v[120:123], a[68:71], v[68:71]
    v_mfma_f32_16x16x32_bf16 v[72:75], v[120:123], a[76:79], v[72:75]
    v_mfma_f32_16x16x32_bf16 v[76:79], v[124:127], a[44:47], v[76:79]
    s_cmp_ge_u32 s92, 4
    s_cselect_b32 s84, s70, s82
    s_add_u32 s84, s84, 6144
    v_mfma_f32_16x16x32_bf16 v[80:83], v[124:127], a[52:55], v[80:83]
    buffer_load_dwordx4 v[120:123], v3, s[60:63], s84 offen sc1
    v_mfma_f32_16x16x32_bf16 v[84:87], v[124:127], a[60:63], v[84:87]
    v_mfma_f32_16x16x32_bf16 v[88:91], v[124:127], a[68:71], v[88:91]
    v_mfma_f32_16x16x32_bf16 v[92:95], v[124:127], a[76:79], v[92:95]
    s_cmp_ge_u32 s92, 4
    s_cselect_b32 s84, s71, s83
    s_add_u32 s84, s84, 6144
    buffer_load_dwordx4 v[124:127], v3, s[60:63], s84 offen sc1
    s_waitcnt vmcnt(8) lgkmcnt(0)
    v_mfma_f32_16x16x32_bf16 v[16:19], v[128:131], a[80:83], v[16:19]
    ds_read_b128 a[36:39], v2 offset:0
    v_mfma_f32_16x16x32_bf16 v[20:23], v[128:131], a[88:91], v[20:23]
    v_mfma_f32_16x16x32_bf16 v[24:27], v[128:131], v[96:99], v[24:27]
    v_mfma_f32_16x16x32_bf16 v[28:31], v[128:131], v[104:107], v[28:31]
    v_mfma_f32_16x16x32_bf16 v[32:35], v[128:131], a[16:19], v[32:35]
    v_mfma_f32_16x16x32_bf16 v[36:39], v[132:135], a[80:83], v[36:39]
    s_cmp_ge_u32 s92, 3
    s_cselect_b32 s84, s68, s80
    s_add_u32 s84, s84, 7168
    v_mfma_f32_16x16x32_bf16 v[40:43], v[132:135], a[88:91], v[40:43]
    buffer_load_dwordx4 v[128:131], v3, s[60:63], s84 offen sc1
    v_mfma_f32_16x16x32_bf16 v[44:47], v[132:135], v[96:99], v[44:47]
    v_mfma_f32_16x16x32_bf16 v[48:51], v[132:135], v[104:107], v[48:51]
    v_mfma_f32_16x16x32_bf16 v[52:55], v[132:135], a[16:19], v[52:55]
    v_mfma_f32_16x16x32_bf16 v[56:59], v[136:139], a[80:83], v[56:59]
    s_cmp_ge_u32 s92, 3
    s_cselect_b32 s84, s69, s81
    s_add_u32 s84, s84, 7168
    v_mfma_f32_16x16x32_bf16 v[60:63], v[136:139], a[88:91], v[60:63]
    buffer_load_dwordx4 v[132:135], v3, s[60:63], s84 offen sc1
    v_mfma_f32_16x16x32_bf16 v[64:67], v[136:139], v[96:99], v[64:67]
    v_mfma_f32_16x16x32_bf16 v[68:71], v[136:139], v[104:107], v[68:71]
    v_mfma_f32_16x16x32_bf16 v[72:75], v[136:139], a[16:19], v[72:75]
    v_mfma_f32_16x16x32_bf16 v[76:79], v[140:143], a[80:83], v[76:79]
    s_cmp_ge_u32 s92, 3
    s_cselect_b32 s84, s70, s82
    s_add_u32 s84, s84, 7168
    v_mfma_f32_16x16x32_bf16 v[80:83], v[140:143], a[88:91], v[80:83]
    buffer_load_dwordx4 v[136:139], v3, s[60:63], s84 offen sc1
    v_mfma_f32_16x16x32_bf16 v[84:87], v[140:143], v[96:99], v[84:87]
    v_mfma_f32_16x16x32_bf16 v[88:91], v[140:143], v[104:107], v[88:91]
    v_mfma_f32_16x16x32_bf16 v[92:95], v[140:143], a[16:19], v[92:95]
    s_cmp_ge_u32 s92, 3
    s_cselect_b32 s84, s71, s83
    s_add_u32 s84, s84, 7168
    buffer_load_dwordx4 v[140:143], v3, s[60:63], s84 offen sc1
    s_waitcnt vmcnt(8) lgkmcnt(0)
    v_mfma_f32_16x16x32_bf16 v[16:19], v[144:147], a[84:87], v[16:19]
    ds_read_b128 a[0:3], v1 offset:2048
    v_mfma_f32_16x16x32_bf16 v[20:23], v[144:147], a[92:95], v[20:23]
    ds_read_b128 a[4:7], v1 offset:4096
    v_mfma_f32_16x16x32_bf16 v[24:27], v[144:147], v[100:103], v[24:27]
    ds_read_b128 a[8:11], v1 offset:6144
    v_mfma_f32_16x16x32_bf16 v[28:31], v[144:147], v[108:111], v[28:31]
    ds_read_b128 a[12:15], v1 offset:8192
    v_mfma_f32_16x16x32_bf16 v[32:35], v[144:147], a[36:39], v[32:35]
    ds_read_b128 a[16:19], v1 offset:10240
    v_mfma_f32_16x16x32_bf16 v[36:39], v[148:151], a[84:87], v[36:39]
    s_cmp_ge_u32 s92, 2
    s_cselect_b32 s84, s68, s80
    s_add_u32 s84, s84, 8192
    v_mfma_f32_16x16x32_bf16 v[40:43], v[148:151], a[92:95], v[40:43]
    buffer_load_dwordx4 v[144:147], v3, s[60:63], s84 offen sc1
    v_mfma_f32_16x16x32_bf16 v[44:47], v[148:151], v[100:103], v[44:47]
    v_mfma_f32_16x16x32_bf16 v[48:51], v[148:151], v[108:111], v[48:51]
    v_mfma_f32_16x16x32_bf16 v[52:55], v[148:151], a[36:39], v[52:55]
    v_mfma_f32_16x16x32_bf16 v[56:59], v[152:155], a[84:87], v[56:59]
    s_cmp_ge_u32 s92, 2
    s_cselect_b32 s84, s69, s81
    s_add_u32 s84, s84, 8192
    v_mfma_f32_16x16x32_bf16 v[60:63], v[152:155], a[92:95], v[60:63]
    buffer_load_dwordx4 v[148:151], v3, s[60:63], s84 offen sc1
    v_mfma_f32_16x16x32_bf16 v[64:67], v[152:155], v[100:103], v[64:67]
    v_mfma_f32_16x16x32_bf16 v[68:71], v[152:155], v[108:111], v[68:71]
    v_mfma_f32_16x16x32_bf16 v[72:75], v[152:155], a[36:39], v[72:75]
    v_mfma_f32_16x16x32_bf16 v[76:79], v[156:159], a[84:87], v[76:79]
    s_cmp_ge_u32 s92, 2
    s_cselect_b32 s84, s70, s82
    s_add_u32 s84, s84, 8192
    v_mfma_f32_16x16x32_bf16 v[80:83], v[156:159], a[92:95], v[80:83]
    buffer_load_dwordx4 v[152:155], v3, s[60:63], s84 offen sc1
    v_mfma_f32_16x16x32_bf16 v[84:87], v[156:159], v[100:103], v[84:87]
    v_mfma_f32_16x16x32_bf16 v[88:91], v[156:159], v[108:111], v[88:91]
    v_mfma_f32_16x16x32_bf16 v[92:95], v[156:159], a[36:39], v[92:95]
    s_cmp_ge_u32 s92, 2
    s_cselect_b32 s84, s71, s83
    s_add_u32 s84, s84, 8192
    buffer_load_dwordx4 v[156:159], v3, s[60:63], s84 offen sc1
    s_waitcnt vmcnt(8) lgkmcnt(0)
    v_mfma_f32_16x16x32_bf16 v[16:19], v[112:115], a[0:3], v[16:19]
    ds_read_b128 a[20:23], v2 offset:2048
    v_mfma_f32_16x16x32_bf16 v[20:23], v[112:115], a[4:7], v[20:23]
    ds_read_b128 a[24:27], v2 offset:4096
    v_mfma_f32_16x16x32_bf16 v[24:27], v[112:115], a[8:11], v[24:27]
    ds_read_b128 a[28:31], v2 offset:6144
    v_mfma_f32_16x16x32_bf16 v[28:31], v[112:115], a[12:15], v[28:31]
    ds_read_b128 a[32:35], v2 offset:8192
    v_mfma_f32_16x16x32_bf16 v[32:35], v[112:115], a[16:19], v[32:35]
    ds_read_b128 a[36:39], v2 offset:10240
    v_mfma_f32_16x16x32_bf16 v[36:39], v[116:119], a[0:3], v[36:39]
    s_cmp_ge_u32 s92, 1
    s_cselect_b32 s84, s68, s80
    s_add_u32 s84, s84, 9216
    v_mfma_f32_16x16x32_bf16 v[40:43], v[116:119], a[4:7], v[40:43]
    buffer_load_dwordx4 v[112:115], v3, s[60:63], s84 offen sc1
    v_mfma_f32_16x16x32_bf16 v[44:47], v[116:119], a[8:11], v[44:47]
    v_mfma_f32_16x16x32_bf16 v[48:51], v[116:119], a[12:15], v[48:51]
    v_mfma_f32_16x16x32_bf16 v[52:55], v[116:119], a[16:19], v[52:55]
    v_mfma_f32_16x16x32_bf16 v[56:59], v[120:123], a[0:3], v[56:59]
    s_cmp_ge_u32 s92, 1
    s_cselect_b32 s84, s69, s81
    s_add_u32 s84, s84, 9216
    v_mfma_f32_16x16x32_bf16 v[60:63], v[120:123], a[4:7], v[60:63]
    buffer_load_dwordx4 v[116:119], v3, s[60:63], s84 offen sc1
    v_mfma_f32_16x16x32_bf16 v[64:67], v[120:123], a[8:11], v[64:67]
    v_mfma_f32_16x16x32_bf16 v[68:71], v[120:123], a[12:15], v[68:71]
    v_mfma_f32_16x16x32_bf16 v[72:75], v[120:123], a[16:19], v[72:75]
    v_mfma_f32_16x16x32_bf16 v[76:79], v[124:127], a[0:3], v[76:79]
    s_cmp_ge_u32 s92, 1
    s_cselect_b32 s84, s70, s82
    s_add_u32 s84, s84, 9216
    v_mfma_f32_16x16x32_bf16 v[80:83], v[124:127], a[4:7], v[80:83]
    buffer_load_dwordx4 v[120:123], v3, s[60:63], s84 offen sc1
    v_mfma_f32_16x16x32_bf16 v[84:87], v[124:127], a[8:11], v[84:87]
    v_mfma_f32_16x16x32_bf16 v[88:91], v[124:127], a[12:15], v[88:91]
    v_mfma_f32_16x16x32_bf16 v[92:95], v[124:127], a[16:19], v[92:95]
    s_cmp_ge_u32 s92, 1
    s_cselect_b32 s84, s71, s83
    s_add_u32 s84, s84, 9216
    buffer_load_dwordx4 v[124:127], v3, s[60:63], s84 offen sc1
    s_waitcnt vmcnt(8) lgkmcnt(0)
    v_mfma_f32_16x16x32_bf16 v[16:19], v[128:131], a[20:23], v[16:19]
    ds_read_b128 a[0:3], v1 offset:12288
    v_mfma_f32_16x16x32_bf16 v[20:23], v[128:131], a[24:27], v[20:23]
    ds_read_b128 a[4:7], v1 offset:14336
    v_mfma_f32_16x16x32_bf16 v[24:27], v[128:131], a[28:31], v[24:27]
    ds_read_b128 a[8:11], v1 offset:16384
    v_mfma_f32_16x16x32_bf16 v[28:31], v[128:131], a[32:35], v[28:31]
    ds_read_b128 a[12:15], v1 offset:18432
    v_mfma_f32_16x16x32_bf16 v[32:35], v[128:131], a[36:39], v[32:35]
    ds_read_b128 a[16:19], v1 offset:20480
    v_mfma_f32_16x16x32_bf16 v[36:39], v[132:135], a[20:23], v[36:39]
    v_mfma_f32_16x16x32_bf16 v[40:43], v[132:135], a[24:27], v[40:43]
    v_mfma_f32_16x16x32_bf16 v[44:47], v[132:135], a[28:31], v[44:47]
    v_mfma_f32_16x16x32_bf16 v[48:51], v[132:135], a[32:35], v[48:51]
    v_mfma_f32_16x16x32_bf16 v[52:55], v[132:135], a[36:39], v[52:55]
    v_mfma_f32_16x16x32_bf16 v[56:59], v[136:139], a[20:23], v[56:59]
    v_mfma_f32_16x16x32_bf16 v[60:63], v[136:139], a[24:27], v[60:63]
    v_mfma_f32_16x16x32_bf16 v[64:67], v[136:139], a[28:31], v[64:67]
    v_mfma_f32_16x16x32_bf16 v[68:71], v[136:139], a[32:35], v[68:71]
    v_mfma_f32_16x16x32_bf16 v[72:75], v[136:139], a[36:39], v[72:75]
    v_mfma_f32_16x16x32_bf16 v[76:79], v[140:143], a[20:23], v[76:79]
    v_mfma_f32_16x16x32_bf16 v[80:83], v[140:143], a[24:27], v[80:83]
    v_mfma_f32_16x16x32_bf16 v[84:87], v[140:143], a[28:31], v[84:87]
    v_mfma_f32_16x16x32_bf16 v[88:91], v[140:143], a[32:35], v[88:91]
    v_mfma_f32_16x16x32_bf16 v[92:95], v[140:143], a[36:39], v[92:95]
    s_waitcnt vmcnt(4) lgkmcnt(0)
    v_mfma_f32_16x16x32_bf16 v[16:19], v[144:147], a[0:3], v[16:19]
    ds_read_b128 a[20:23], v2 offset:12288
    v_mfma_f32_16x16x32_bf16 v[20:23], v[144:147], a[4:7], v[20:23]
    ds_read_b128 a[24:27], v2 offset:14336
    v_mfma_f32_16x16x32_bf16 v[24:27], v[144:147], a[8:11], v[24:27]
    ds_read_b128 a[28:31], v2 offset:16384
    v_mfma_f32_16x16x32_bf16 v[28:31], v[144:147], a[12:15], v[28:31]
    ds_read_b128 a[32:35], v2 offset:18432
    v_mfma_f32_16x16x32_bf16 v[32:35], v[144:147], a[16:19], v[32:35]
    ds_read_b128 a[36:39], v2 offset:20480
    v_mfma_f32_16x16x32_bf16 v[36:39], v[148:151], a[0:3], v[36:39]
    v_mfma_f32_16x16x32_bf16 v[40:43], v[148:151], a[4:7], v[40:43]
    v_mfma_f32_16x16x32_bf16 v[44:47], v[148:151], a[8:11], v[44:47]
    v_mfma_f32_16x16x32_bf16 v[48:51], v[148:151], a[12:15], v[48:51]
    v_mfma_f32_16x16x32_bf16 v[52:55], v[148:151], a[16:19], v[52:55]
    v_mfma_f32_16x16x32_bf16 v[56:59], v[152:155], a[0:3], v[56:59]
    v_mfma_f32_16x16x32_bf16 v[60:63], v[152:155], a[4:7], v[60:63]
    v_mfma_f32_16x16x32_bf16 v[64:67], v[152:155], a[8:11], v[64:67]
    v_mfma_f32_16x16x32_bf16 v[68:71], v[152:155], a[12:15], v[68:71]
    v_mfma_f32_16x16x32_bf16 v[72:75], v[152:155], a[16:19], v[72:75]
    v_mfma_f32_16x16x32_bf16 v[76:79], v[156:159], a[0:3], v[76:79]
    v_mfma_f32_16x16x32_bf16 v[80:83], v[156:159], a[4:7], v[80:83]
    v_mfma_f32_16x16x32_bf16 v[84:87], v[156:159], a[8:11], v[84:87]
    v_mfma_f32_16x16x32_bf16 v[88:91], v[156:159], a[12:15], v[88:91]
    v_mfma_f32_16x16x32_bf16 v[92:95], v[156:159], a[16:19], v[92:95]
    s_waitcnt vmcnt(0) lgkmcnt(0)
    v_mfma_f32_16x16x32_bf16 v[16:19], v[112:115], a[20:23], v[16:19]
    v_mfma_f32_16x16x32_bf16 v[20:23], v[112:115], a[24:27], v[20:23]
    v_mfma_f32_16x16x32_bf16 v[24:27], v[112:115], a[28:31], v[24:27]
    v_mfma_f32_16x16x32_bf16 v[28:31], v[112:115], a[32:35], v[28:31]
    v_mfma_f32_16x16x32_bf16 v[32:35], v[112:115], a[36:39], v[32:35]
    v_mfma_f32_16x16x32_bf16 v[36:39], v[116:119], a[20:23], v[36:39]
    v_mfma_f32_16x16x32_bf16 v[40:43], v[116:119], a[24:27], v[40:43]
    v_mfma_f32_16x16x32_bf16 v[44:47], v[116:119], a[28:31], v[44:47]
    v_mfma_f32_16x16x32_bf16 v[48:51], v[116:119], a[32:35], v[48:51]
    v_mfma_f32_16x16x32_bf16 v[52:55], v[116:119], a[36:39], v[52:55]
    v_mfma_f32_16x16x32_bf16 v[56:59], v[120:123], a[20:23], v[56:59]
    v_mfma_f32_16x16x32_bf16 v[60:63], v[120:123], a[24:27], v[60:63]
    v_mfma_f32_16x16x32_bf16 v[64:67], v[120:123], a[28:31], v[64:67]
    v_mfma_f32_16x16x32_bf16 v[68:71], v[120:123], a[32:35], v[68:71]
    v_mfma_f32_16x16x32_bf16 v[72:75], v[120:123], a[36:39], v[72:75]
    v_mfma_f32_16x16x32_bf16 v[76:79], v[124:127], a[20:23], v[76:79]
    v_mfma_f32_16x16x32_bf16 v[80:83], v[124:127], a[24:27], v[80:83]
    v_mfma_f32_16x16x32_bf16 v[84:87], v[124:127], a[28:31], v[84:87]
    v_mfma_f32_16x16x32_bf16 v[88:91], v[124:127], a[32:35], v[88:91]
    v_mfma_f32_16x16x32_bf16 v[92:95], v[124:127], a[36:39], v[92:95]
    s_branch L_g2join_77
L_exit:
    s_endpgm
.section .rodata,"a"
.p2align 6
.amdhsa_kernel gated_mix__ssm_conv_s5__ssm_conv_s4__prompt_kernel
  .amdhsa_next_free_vgpr 256
  .amdhsa_next_free_sgpr 102
  .amdhsa_accum_offset 160
  .amdhsa_group_segment_fixed_size 0
  .amdhsa_kernarg_size 176
  .amdhsa_user_sgpr_count 2
  .amdhsa_user_sgpr_kernarg_segment_ptr 1
  .amdhsa_system_sgpr_workgroup_id_x 1
  .amdhsa_float_denorm_mode_32 3
.end_amdhsa_kernel
```
